```python
import torch

def _softmax(x, axis=-1):
    return torch.softmax(x, dim=axis)
def _gelu(x):
    return torch.nn.functional.gelu(x, approximate="tanh")
def _silu(x):
    return torch.nn.functional.silu(x)
def _sigmoid(x):
    return torch.sigmoid(x)
def _layernorm(x, axis=-1, eps=1e-5):
    m = x.mean(dim=axis, keepdim=True)
    v = x.var(dim=axis, keepdim=True, unbiased=False)
    return (x - m) / torch.sqrt(v + eps)
def _scatter_add(tgt, idx, src, axis=0):
    return tgt.clone().index_add_(axis, idx, src)
def _segment_sum(src, seg, n):
    out = torch.zeros((n,) + src.shape[1:], dtype=src.dtype)
    return out.index_add_(0, seg, src)
def _pad(x, pw):
    flat = tuple(v for pair in reversed(pw) for v in pair)
    return torch.nn.functional.pad(x, flat)

kernel_name = 'recurrent_scan__gqa_block_cached__glu_gated_geglu__decode'

def setup_inputs():

    _w = (lambda a: (lambda t: t.to(torch.bfloat16) if t.is_floating_point() else t)(torch.as_tensor(a)))
    def _A_setup():
        B, Sq, D = 1, 1, 512
        Hq, Hkv, Sk, Dh = 32, 8, 65536, 128
        assert Hq % Hkv == 0, (Hq, Hkv)
        return {
            "x": _w((lambda *s: torch.randn(*s, dtype=torch.bfloat16) * 0.4)(B, Sq, D)),
            "k_cache": _w((lambda *s: torch.randn(*s, dtype=torch.bfloat16) * 1.6)(B, Hkv, Sk, Dh)),
            "v_cache": _w((lambda *s: torch.randn(*s, dtype=torch.bfloat16) * 1.6)(B, Hkv, Sk, Dh)),
            "wq": _w((lambda *s: torch.randn(*s, dtype=torch.bfloat16) * 1.6)(D, Hq * Dh) * (D ** -0.5)),
            "wo": _w((lambda *s: torch.randn(*s, dtype=torch.bfloat16) * 1.6)(Hq * Dh, D) * ((Hq * Dh) ** -0.5)),
        }
    _A_in = _A_setup()

    def _B_setup():
        B, S, Dm, Df = 1, 1, 512, 1792
        return {
            "x": _w((lambda *s: torch.randn(*s, dtype=torch.bfloat16) * 0.4)(B, S, Dm)),
            "w_gate": _w((lambda *s: torch.randn(*s, dtype=torch.bfloat16) * 1.6)(Dm, Df) * (Dm ** -0.5)),
            "w_up": _w((lambda *s: torch.randn(*s, dtype=torch.bfloat16) * 1.6)(Dm, Df) * (Dm ** -0.5)),
            "w_down": _w((lambda *s: torch.randn(*s, dtype=torch.bfloat16) * 1.6)(Df, Dm) * (Df ** -0.5)),
        }
    _B_in = _B_setup()

    return {
        "A_x": _A_in["x"],
        "A_k_cache": _A_in["k_cache"],
        "A_v_cache": _A_in["v_cache"],
        "A_wq": _A_in["wq"],
        "A_wo": _A_in["wo"],
        "B_x": _B_in["x"],
        "B_w_gate": _B_in["w_gate"],
        "B_w_up": _B_in["w_up"],
        "B_w_down": _B_in["w_down"],
    }

def reference(A_x, A_k_cache, A_v_cache, A_wq, A_wo, B_x, B_w_gate, B_w_up, B_w_down):
    def _A_ref(x, k_cache, v_cache, wq, wo):
        B, Sq, D = x.shape
        Hq, Dh = 32, 128
        Hkv = k_cache.shape[1]
        rep = Hq // Hkv
        q = (lambda x, *d: x.permute(*d))((x @ wq).reshape(B, Sq, Hq, Dh), 0, 2, 1, 3)
        k = (lambda x, n, axis: torch.repeat_interleave(x, n, dim=axis))(k_cache, rep, axis=1)
        v = (lambda x, n, axis: torch.repeat_interleave(x, n, dim=axis))(v_cache, rep, axis=1)
        scores = torch.einsum("bhqd,bhkd->bhqk", q, k) * (Dh ** -0.5)
        p = _softmax(scores, axis=-1)
        o = torch.einsum("bhqk,bhkd->bhqd", p, v)
        return (lambda x, *d: x.permute(*d))(o, 0, 2, 1, 3).reshape(B, Sq, Hq * Dh) @ wo

    def _B_ref(x, w_gate, w_up, w_down):
        g = torch.einsum("bsd,df->bsf", x, w_gate)
        u = torch.einsum("bsd,df->bsf", x, w_up)
        h = _gelu(g) * u
        return torch.einsum("bsf,fd->bsd", h, w_down)

    x = A_x
    xn = _layernorm(x, axis=-1)
    s = _A_ref(xn, A_k_cache, A_v_cache, A_wq, A_wo)
    g = _silu(_B_ref(xn, B_w_gate, B_w_up, B_w_down))
    return x + s * g
```

```asm
; @launch grid=(256,1,1) block=(512,1,1) lds=81920
.amdgcn_target "amdgcn-amd-amdhsa--gfx950"
.text
.globl recurrent_scan__gqa_block_cached__glu_gated_geglu__decode_kernel
.p2align 8
.type recurrent_scan__gqa_block_cached__glu_gated_geglu__decode_kernel,@function
recurrent_scan__gqa_block_cached__glu_gated_geglu__decode_kernel:
  s_cmp_ge_u32 s2, 256
  s_cbranch_scc1 L_end
  s_load_dwordx16 s[4:19], s[0:1], 0
  s_load_dwordx8 s[20:27], s[0:1], 64
  v_and_b32 v1, 63, v0
  v_lshrrev_b32 v7, 6, v0
  s_nop 0
  v_readfirstlane_b32 s68, v7
  s_and_b32 s69, s2, 7
  s_lshr_b32 s70, s2, 3
  s_lshl_b32 s92, s69, 5
  s_add_u32 s92, s92, s70
  s_mov_b32 s74, 0x05040100
  s_mov_b32 s75, 0x07060302
  s_mov_b32 s76, 0x3db504f3
  s_mov_b32 s77, 0x3fb8aa3b
  s_mov_b32 s78, 0xffff0000
  v_lshlrev_b32 v3, 4, v1
  v_and_b32 v2, 3, v1
  v_lshlrev_b32 v2, 10, v2
  v_bfe_u32 v7, v1, 2, 1
  v_lshl_add_u32 v2, v7, 8, v2
  v_lshrrev_b32 v7, 3, v1
  v_lshl_add_u32 v2, v7, 4, v2
  v_lshrrev_b32 v14, 3, v1
  v_lshlrev_b32 v14, 14, v14
  v_and_b32 v7, 7, v1
  v_lshl_add_u32 v14, v7, 4, v14
  v_lshlrev_b32 v13, 2, v1
  v_mov_b32 v8, 0
  s_lshl_b32 s72, s69, 24
  s_lshl_b32 s73, s70, 3
  s_add_u32 s73, s73, s68
  s_lshl_b32 s73, s73, 12
  s_add_u32 s72, s72, s73
  s_mul_i32 s3, s69, 3
  s_lshr_b32 s91, s2, 1
  s_and_b32 s73, s2, 1
  s_xor_b32 s73, s73, 0
  s_lshl_b32 s73, s73, 7
  s_add_u32 s91, s91, s73
  s_cmp_lt_u32 s91, 112
  s_cselect_b32 s95, 1, 0
  s_cselect_b32 s79, s91, 0
  s_and_b32 s73, s70, 3
  s_lshl_b32 s73, s73, 20
  s_lshl_b32 s88, s69, 10
  s_add_u32 s73, s73, s88
  s_lshr_b32 s88, s70, 2
  s_lshl_b32 s88, s88, 7
  s_add_u32 s73, s73, s88
  s_lshl_b32 s93, s69, 11
  s_add_u32 s93, s93, 4096
  s_waitcnt lgkmcnt(0)
  s_mov_b32 s56, s4
  s_mov_b32 s57, s5
  s_mov_b32 s58, 0x400
  s_mov_b32 s59, 0x00020000
  s_mov_b32 s36, s10
  s_mov_b32 s37, s11
  s_mov_b32 s38, 0x400000
  s_mov_b32 s39, 0x00020000
  s_mov_b32 s64, s26
  s_mov_b32 s65, s27
  s_mov_b32 s66, 0x1000000
  s_mov_b32 s67, 0x00020000
  s_load_dword s71, s[26:27], 0
  s_cmp_lg_u32 s68, 0
  s_cbranch_scc1 Lw_1
  buffer_load_dwordx4 v[8:11], v3, s[56:59], 0 offen
  s_add_u32 s88, s73, 0
  buffer_load_dwordx4 v[64:67], v14, s[36:39], s88 offen nt
  s_add_u32 s88, s73, 8192
  buffer_load_dwordx4 v[68:71], v14, s[36:39], s88 offen nt
  s_add_u32 s88, s73, 131072
  buffer_load_dwordx4 v[72:75], v14, s[36:39], s88 offen nt
  s_add_u32 s88, s73, 139264
  buffer_load_dwordx4 v[76:79], v14, s[36:39], s88 offen nt
  s_add_u32 s88, s73, 262144
  buffer_load_dwordx4 v[80:83], v14, s[36:39], s88 offen nt
  s_add_u32 s88, s73, 270336
  buffer_load_dwordx4 v[84:87], v14, s[36:39], s88 offen nt
  s_add_u32 s88, s73, 393216
  buffer_load_dwordx4 v[88:91], v14, s[36:39], s88 offen nt
  s_add_u32 s88, s73, 401408
  buffer_load_dwordx4 v[92:95], v14, s[36:39], s88 offen nt
  s_add_u32 s88, s73, 524288
  buffer_load_dwordx4 v[96:99], v14, s[36:39], s88 offen nt
  s_add_u32 s88, s73, 532480
  buffer_load_dwordx4 v[100:103], v14, s[36:39], s88 offen nt
  s_add_u32 s88, s73, 655360
  buffer_load_dwordx4 v[104:107], v14, s[36:39], s88 offen nt
  s_add_u32 s88, s73, 663552
  buffer_load_dwordx4 v[108:111], v14, s[36:39], s88 offen nt
  s_add_u32 s88, s73, 786432
  buffer_load_dwordx4 v[112:115], v14, s[36:39], s88 offen nt
  s_add_u32 s88, s73, 794624
  buffer_load_dwordx4 v[116:119], v14, s[36:39], s88 offen nt
  s_add_u32 s88, s73, 917504
  buffer_load_dwordx4 v[120:123], v14, s[36:39], s88 offen nt
  s_add_u32 s88, s73, 925696
  buffer_load_dwordx4 v[124:127], v14, s[36:39], s88 offen nt
Lw_1:
  s_mov_b32 s28, s6
  s_mov_b32 s29, s7
  s_mov_b32 s30, 0x8000000
  s_mov_b32 s31, 0x00020000
  s_barrier
  s_add_u32 s89, s3, 0
  s_and_b32 s89, s89, 15
  s_lshl_b32 s89, s89, 20
  s_add_u32 s89, s89, s72
  buffer_load_dwordx4 v[128:131], v2, s[28:31], s89 offen offset:0 nt
  buffer_load_dwordx4 v[132:135], v2, s[28:31], s89 offen offset:128 nt
  buffer_load_dwordx4 v[136:139], v2, s[28:31], s89 offen offset:512 nt
  buffer_load_dwordx4 v[140:143], v2, s[28:31], s89 offen offset:640 nt
  s_mov_b32 s32, s8
  s_mov_b32 s33, s9
  s_mov_b32 s34, 0x8000000
  s_mov_b32 s35, 0x00020000
  s_mov_b32 s40, s12
  s_mov_b32 s41, s13
  s_mov_b32 s42, 0x400000
  s_mov_b32 s43, 0x00020000
  s_mov_b32 s44, s16
  s_mov_b32 s45, s17
  s_mov_b32 s46, 0x1c0000
  s_mov_b32 s47, 0x00020000
  s_mov_b32 s48, s18
  s_mov_b32 s49, s19
  s_mov_b32 s50, 0x1c0000
  s_mov_b32 s51, 0x00020000
  s_mov_b32 s52, s20
  s_mov_b32 s53, s21
  s_mov_b32 s54, 0x1c0000
  s_mov_b32 s55, 0x00020000
  s_mov_b32 s60, s22
  s_mov_b32 s61, s23
  s_mov_b32 s62, 0x400
  s_mov_b32 s63, 0x00020000
  s_waitcnt lgkmcnt(0)
  s_add_u32 s71, s71, 0x9e3779b9
  s_cmp_lg_u32 s68, 0
  s_cbranch_scc1 Lw_2
  s_waitcnt vmcnt(20)
  v_lshlrev_b32 v16, 16, v8
  v_and_b32 v17, s78, v8
  v_lshlrev_b32 v18, 16, v9
  v_and_b32 v19, s78, v9
  v_lshlrev_b32 v20, 16, v10
  v_and_b32 v21, s78, v10
  v_lshlrev_b32 v22, 16, v11
  v_and_b32 v23, s78, v11
  v_readfirstlane_b32 s14, v16
  s_nop 1
  v_subrev_f32 v28, s14, v16
  v_subrev_f32 v29, s14, v17
  v_subrev_f32 v30, s14, v18
  v_subrev_f32 v31, s14, v19
  v_subrev_f32 v32, s14, v20
  v_subrev_f32 v33, s14, v21
  v_subrev_f32 v34, s14, v22
  v_subrev_f32 v35, s14, v23
  v_add_f32 v24, v28, v29
  v_mul_f32 v25, v28, v28
  v_add_f32 v26, v30, v31
  v_mul_f32 v27, v29, v29
  v_add_f32 v24, v24, v32
  v_fmac_f32 v25, v30, v30
  v_add_f32 v26, v26, v33
  v_fmac_f32 v27, v31, v31
  v_add_f32 v24, v24, v34
  v_fmac_f32 v25, v32, v32
  v_add_f32 v26, v26, v35
  v_fmac_f32 v27, v33, v33
  v_fmac_f32 v25, v34, v34
  v_add_f32 v24, v24, v26
  v_fmac_f32 v27, v35, v35
  v_add_f32 v25, v25, v27
  s_nop 0
  s_nop 0
  v_add_f32_dpp v24, v24, v24 quad_perm:[1,0,3,2] row_mask:0xf bank_mask:0xf
  v_add_f32_dpp v25, v25, v25 quad_perm:[1,0,3,2] row_mask:0xf bank_mask:0xf
  s_nop 0
  v_add_f32_dpp v24, v24, v24 quad_perm:[2,3,0,1] row_mask:0xf bank_mask:0xf
  v_add_f32_dpp v25, v25, v25 quad_perm:[2,3,0,1] row_mask:0xf bank_mask:0xf
  s_nop 0
  v_add_f32_dpp v24, v24, v24 row_half_mirror row_mask:0xf bank_mask:0xf
  v_add_f32_dpp v25, v25, v25 row_half_mirror row_mask:0xf bank_mask:0xf
  s_nop 0
  v_add_f32_dpp v24, v24, v24 row_mirror row_mask:0xf bank_mask:0xf
  v_add_f32_dpp v25, v25, v25 row_mirror row_mask:0xf bank_mask:0xf
  v_mov_b32 v26, v24
  v_mov_b32 v27, v25
  s_nop 0
  s_nop 0
  v_permlane16_swap_b32 v24, v26
  v_permlane16_swap_b32 v25, v27
  v_add_f32 v24, v24, v26
  v_add_f32 v25, v25, v27
  v_mov_b32 v26, v24
  v_mov_b32 v27, v25
  s_nop 0
  s_nop 0
  v_permlane32_swap_b32 v24, v26
  v_permlane32_swap_b32 v25, v27
  v_add_f32 v24, v24, v26
  v_add_f32 v25, v25, v27
  v_mul_f32 v24, 0x3b000000, v24
  v_mul_f32 v25, 0x3b000000, v25
  v_fma_f32 v25, -v24, v24, v25
  v_max_f32 v25, 0, v25
  v_add_f32 v24, s14, v24
Lw_2:
  s_add_u32 s89, s3, 1
  s_and_b32 s89, s89, 15
  s_lshl_b32 s89, s89, 20
  s_add_u32 s89, s89, s72
  buffer_load_dwordx4 v[144:147], v2, s[28:31], s89 offen offset:0 nt
  s_cmp_lg_u32 s68, 0
  s_cbranch_scc1 Lw_3
  v_cvt_pk_bf16_f32 v26, v24, v25
  v_lshlrev_b32 v24, 16, v26
  v_and_b32 v25, s78, v26
  v_add_f32 v25, 0x3727c5ac, v25
  v_cvt_pk_bf16_f32 v25, v25, v25
  v_and_b32 v25, s78, v25
  v_sqrt_f32 v25, v25
  v_sub_f32 v28, v16, v24
  v_sub_f32 v29, v17, v24
  v_sub_f32 v30, v18, v24
  v_sub_f32 v31, v19, v24
  v_sub_f32 v32, v20, v24
  v_sub_f32 v33, v21, v24
  v_sub_f32 v34, v22, v24
  v_sub_f32 v35, v23, v24
  v_cvt_pk_bf16_f32 v25, v25, v25
  v_and_b32 v25, s78, v25
  v_rcp_f32 v26, v25
  v_cvt_pk_bf16_f32 v36, v28, v29
  v_cvt_pk_bf16_f32 v37, v30, v31
  v_cvt_pk_bf16_f32 v38, v32, v33
  v_cvt_pk_bf16_f32 v39, v34, v35
  v_lshlrev_b32 v28, 16, v36
  v_and_b32 v29, s78, v36
  v_lshlrev_b32 v30, 16, v37
  v_and_b32 v31, s78, v37
  v_lshlrev_b32 v32, 16, v38
  v_and_b32 v33, s78, v38
  v_lshlrev_b32 v34, 16, v39
  v_and_b32 v35, s78, v39
  v_mul_f32 v16, v28, v26
  v_mul_f32 v17, v29, v26
  v_mul_f32 v18, v30, v26
  v_mul_f32 v19, v31, v26
  v_mul_f32 v20, v32, v26
  v_mul_f32 v21, v33, v26
  v_mul_f32 v22, v34, v26
  v_mul_f32 v23, v35, v26
  v_fma_f32 v28, -v16, v25, v28
  v_fma_f32 v29, -v17, v25, v29
  v_fma_f32 v30, -v18, v25, v30
  v_fma_f32 v31, -v19, v25, v31
  v_fma_f32 v32, -v20, v25, v32
  v_fma_f32 v33, -v21, v25, v33
  v_fma_f32 v34, -v22, v25, v34
  v_fma_f32 v35, -v23, v25, v35
  v_fma_f32 v16, v28, v26, v16
  v_fma_f32 v17, v29, v26, v17
  v_fma_f32 v18, v30, v26, v18
  v_fma_f32 v19, v31, v26, v19
  v_fma_f32 v20, v32, v26, v20
  v_fma_f32 v21, v33, v26, v21
  v_fma_f32 v22, v34, v26, v22
  v_fma_f32 v23, v35, v26, v23
  v_cvt_pk_bf16_f32 v8, v16, v17
  v_cvt_pk_bf16_f32 v9, v18, v19
  v_cvt_pk_bf16_f32 v10, v20, v21
  v_cvt_pk_bf16_f32 v11, v22, v23
  ds_write_b128 v3, v[8:11] offset:0
  v_mov_b32 v17, 0
  ds_write_b32 v17, v17 offset:11264
  s_and_b32 s73, s70, 3
  s_lshl_b32 s73, s73, 8
  v_lshrrev_b32 v17, 3, v1
  v_lshlrev_b32 v17, 2, v17
  v_add_u32 v17, s73, v17
  ds_read2_b32 v[40:41], v17 offset0:0 offset1:8
  ds_read2_b32 v[42:43], v17 offset0:16 offset1:24
  ds_read2_b32 v[44:45], v17 offset0:32 offset1:40
  ds_read2_b32 v[46:47], v17 offset0:48 offset1:56
Lw_3:
  buffer_load_dwordx4 v[148:151], v2, s[28:31], s89 offen offset:128 nt
  s_cmp_lg_u32 s68, 0
  s_cbranch_scc1 Lw_4
  s_waitcnt vmcnt(6)
  s_waitcnt lgkmcnt(0)
  v_perm_b32 v16, v68, v64, s74
  v_perm_b32 v17, v68, v64, s75
  v_perm_b32 v18, v69, v65, s74
  v_perm_b32 v19, v69, v65, s75
  v_perm_b32 v20, v70, v66, s74
  v_perm_b32 v21, v70, v66, s75
  v_perm_b32 v22, v71, v67, s74
  v_perm_b32 v23, v71, v67, s75
  v_dot2_f32_bf16 v32, v16, v40, 0
  v_dot2_f32_bf16 v33, v17, v40, 0
  v_dot2_f32_bf16 v34, v18, v40, 0
  v_dot2_f32_bf16 v35, v19, v40, 0
  v_dot2_f32_bf16 v36, v20, v40, 0
  v_dot2_f32_bf16 v37, v21, v40, 0
  v_dot2_f32_bf16 v38, v22, v40, 0
  v_dot2_f32_bf16 v39, v23, v40, 0
  v_perm_b32 v16, v76, v72, s74
  v_perm_b32 v17, v76, v72, s75
  v_perm_b32 v18, v77, v73, s74
  v_perm_b32 v19, v77, v73, s75
  v_perm_b32 v20, v78, v74, s74
  v_perm_b32 v21, v78, v74, s75
  v_perm_b32 v22, v79, v75, s74
  v_perm_b32 v23, v79, v75, s75
  v_dot2c_f32_bf16 v32, v16, v41
  v_dot2c_f32_bf16 v33, v17, v41
  v_dot2c_f32_bf16 v34, v18, v41
  v_dot2c_f32_bf16 v35, v19, v41
  v_dot2c_f32_bf16 v36, v20, v41
  v_dot2c_f32_bf16 v37, v21, v41
  v_dot2c_f32_bf16 v38, v22, v41
  v_dot2c_f32_bf16 v39, v23, v41
  v_perm_b32 v16, v84, v80, s74
  v_perm_b32 v17, v84, v80, s75
  v_perm_b32 v18, v85, v81, s74
  v_perm_b32 v19, v85, v81, s75
  v_perm_b32 v20, v86, v82, s74
  v_perm_b32 v21, v86, v82, s75
  v_perm_b32 v22, v87, v83, s74
  v_perm_b32 v23, v87, v83, s75
  v_dot2c_f32_bf16 v32, v16, v42
  v_dot2c_f32_bf16 v33, v17, v42
  v_dot2c_f32_bf16 v34, v18, v42
  v_dot2c_f32_bf16 v35, v19, v42
  v_dot2c_f32_bf16 v36, v20, v42
  v_dot2c_f32_bf16 v37, v21, v42
  v_dot2c_f32_bf16 v38, v22, v42
  v_dot2c_f32_bf16 v39, v23, v42
  v_perm_b32 v16, v92, v88, s74
  v_perm_b32 v17, v92, v88, s75
  v_perm_b32 v18, v93, v89, s74
  v_perm_b32 v19, v93, v89, s75
  v_perm_b32 v20, v94, v90, s74
  v_perm_b32 v21, v94, v90, s75
  v_perm_b32 v22, v95, v91, s74
  v_perm_b32 v23, v95, v91, s75
  v_dot2c_f32_bf16 v32, v16, v43
  v_dot2c_f32_bf16 v33, v17, v43
  v_dot2c_f32_bf16 v34, v18, v43
  v_dot2c_f32_bf16 v35, v19, v43
  v_dot2c_f32_bf16 v36, v20, v43
  v_dot2c_f32_bf16 v37, v21, v43
  v_dot2c_f32_bf16 v38, v22, v43
  v_dot2c_f32_bf16 v39, v23, v43
  v_perm_b32 v16, v100, v96, s74
  v_perm_b32 v17, v100, v96, s75
  v_perm_b32 v18, v101, v97, s74
  v_perm_b32 v19, v101, v97, s75
  v_perm_b32 v20, v102, v98, s74
  v_perm_b32 v21, v102, v98, s75
  v_perm_b32 v22, v103, v99, s74
  v_perm_b32 v23, v103, v99, s75
  v_dot2c_f32_bf16 v32, v16, v44
  v_dot2c_f32_bf16 v33, v17, v44
  v_dot2c_f32_bf16 v34, v18, v44
  v_dot2c_f32_bf16 v35, v19, v44
  v_dot2c_f32_bf16 v36, v20, v44
  v_dot2c_f32_bf16 v37, v21, v44
  v_dot2c_f32_bf16 v38, v22, v44
  v_dot2c_f32_bf16 v39, v23, v44
  v_perm_b32 v16, v108, v104, s74
  v_perm_b32 v17, v108, v104, s75
  v_perm_b32 v18, v109, v105, s74
  v_perm_b32 v19, v109, v105, s75
  v_perm_b32 v20, v110, v106, s74
  v_perm_b32 v21, v110, v106, s75
  v_perm_b32 v22, v111, v107, s74
  v_perm_b32 v23, v111, v107, s75
  v_dot2c_f32_bf16 v32, v16, v45
  v_dot2c_f32_bf16 v33, v17, v45
  v_dot2c_f32_bf16 v34, v18, v45
  v_dot2c_f32_bf16 v35, v19, v45
  v_dot2c_f32_bf16 v36, v20, v45
  v_dot2c_f32_bf16 v37, v21, v45
  v_dot2c_f32_bf16 v38, v22, v45
  v_dot2c_f32_bf16 v39, v23, v45
  v_perm_b32 v16, v116, v112, s74
  v_perm_b32 v17, v116, v112, s75
  v_perm_b32 v18, v117, v113, s74
  v_perm_b32 v19, v117, v113, s75
  v_perm_b32 v20, v118, v114, s74
  v_perm_b32 v21, v118, v114, s75
  v_perm_b32 v22, v119, v115, s74
  v_perm_b32 v23, v119, v115, s75
  v_dot2c_f32_bf16 v32, v16, v46
  v_dot2c_f32_bf16 v33, v17, v46
  v_dot2c_f32_bf16 v34, v18, v46
  v_dot2c_f32_bf16 v35, v19, v46
  v_dot2c_f32_bf16 v36, v20, v46
  v_dot2c_f32_bf16 v37, v21, v46
  v_dot2c_f32_bf16 v38, v22, v46
  v_dot2c_f32_bf16 v39, v23, v46
  v_perm_b32 v16, v124, v120, s74
  v_perm_b32 v17, v124, v120, s75
  v_perm_b32 v18, v125, v121, s74
  v_perm_b32 v19, v125, v121, s75
  v_perm_b32 v20, v126, v122, s74
  v_perm_b32 v21, v126, v122, s75
  v_perm_b32 v22, v127, v123, s74
  v_perm_b32 v23, v127, v123, s75
  v_dot2c_f32_bf16 v32, v16, v47
  v_dot2c_f32_bf16 v33, v17, v47
  v_dot2c_f32_bf16 v34, v18, v47
  v_dot2c_f32_bf16 v35, v19, v47
  v_dot2c_f32_bf16 v36, v20, v47
  v_dot2c_f32_bf16 v37, v21, v47
  v_dot2c_f32_bf16 v38, v22, v47
  v_dot2c_f32_bf16 v39, v23, v47
  s_nop 0
  s_nop 1
  v_permlane32_swap_b32 v32, v36
  v_permlane32_swap_b32 v33, v37
  v_permlane32_swap_b32 v34, v38
  v_permlane32_swap_b32 v35, v39
  v_add_f32 v32, v32, v36
  v_add_f32 v33, v33, v37
  v_add_f32 v34, v34, v38
  v_add_f32 v35, v35, v39
  s_nop 1
  v_permlane16_swap_b32 v32, v34
  v_permlane16_swap_b32 v33, v35
  v_add_f32 v32, v32, v34
  v_add_f32 v33, v33, v35
  s_nop 1
  v_add_f32_dpp v32, v32, v32 row_ror:8 row_mask:0xf bank_mask:0x3
  v_add_f32_dpp v32, v33, v33 row_ror:8 row_mask:0xf bank_mask:0xc
  v_mov_b32 v25, s71
  v_mov_b32 v27, s71
  v_mov_b32 v24, v32
  v_mov_b32_dpp v26, v32 row_ror:8 row_mask:0xf bank_mask:0xf
  v_and_b32 v28, 7, v1
  v_lshlrev_b32 v28, 6, v28
  v_lshrrev_b32 v29, 5, v1
  v_lshl_add_u32 v28, v29, 5, v28
  v_bfe_u32 v29, v1, 4, 1
  v_lshl_add_u32 v28, v29, 4, v28
  s_lshl_b32 s73, s92, 9
  s_add_u32 s73, s73, 2228224
  s_mov_b32 exec_lo, 0x00ff00ff
  s_mov_b32 exec_hi, 0x00ff00ff
  buffer_store_dwordx4 v[24:27], v28, s[64:67], s73 offen sc1
  s_mov_b64 exec, -1
Lw_4:
  s_cmp_eq_u32 s68, 0
  s_cbranch_scc1 Lsk_5
  s_waitcnt vmcnt(5)
Lsk_5:
  buffer_load_dwordx4 v[152:155], v2, s[28:31], s89 offen offset:512 nt
  v_lshrrev_b32 v21, 5, v1
  v_lshlrev_b32 v21, 11, v21
  v_and_b32 v22, 31, v1
  v_lshl_add_u32 v12, v22, 4, v21
  v_mov_b32 v4, 0xff800000
  v_mov_b32 v5, 0
  s_waitcnt vmcnt(5)
  buffer_load_dwordx4 v[156:159], v2, s[28:31], s89 offen offset:640 nt
  s_waitcnt vmcnt(5)
  s_add_u32 s89, s3, 2
  s_and_b32 s89, s89, 15
  s_lshl_b32 s89, s89, 20
  s_add_u32 s89, s89, s72
  buffer_load_dwordx4 v[160:163], v2, s[28:31], s89 offen offset:0 nt
  s_waitcnt vmcnt(5)
  buffer_load_dwordx4 v[164:167], v2, s[28:31], s89 offen offset:128 nt
  s_waitcnt vmcnt(5)
  buffer_load_dwordx4 v[168:171], v2, s[28:31], s89 offen offset:512 nt
  s_waitcnt vmcnt(5)
  buffer_load_dwordx4 v[172:175], v2, s[28:31], s89 offen offset:640 nt
  s_waitcnt vmcnt(5)
  s_add_u32 s89, s3, 3
  s_and_b32 s89, s89, 15
  s_lshl_b32 s89, s89, 20
  s_add_u32 s89, s89, s72
  buffer_load_dwordx4 v[176:179], v2, s[28:31], s89 offen offset:0 nt
  s_waitcnt vmcnt(5)
  buffer_load_dwordx4 v[180:183], v2, s[28:31], s89 offen offset:128 nt
  s_waitcnt vmcnt(5)
  buffer_load_dwordx4 v[184:187], v2, s[28:31], s89 offen offset:512 nt
  s_waitcnt vmcnt(5)
  buffer_load_dwordx4 v[188:191], v2, s[28:31], s89 offen offset:640 nt
  s_waitcnt vmcnt(5)
  s_add_u32 s89, s3, 4
  s_and_b32 s89, s89, 15
  s_lshl_b32 s89, s89, 20
  s_add_u32 s89, s89, s72
  buffer_load_dwordx4 v[192:195], v2, s[28:31], s89 offen offset:0 nt
  s_waitcnt vmcnt(5)
  buffer_load_dwordx4 v[196:199], v2, s[28:31], s89 offen offset:128 nt
  s_cmp_lg_u32 s68, 1
  s_cbranch_scc1 Lw_6
  s_lshl_b32 s73, s69, 14
  s_add_u32 s73, s73, 2228224
  buffer_load_dwordx4 v[64:67], v12, s[64:67], s73 offen offset:0 sc1
  buffer_load_dwordx4 v[68:71], v12, s[64:67], s73 offen offset:512 sc1
  buffer_load_dwordx4 v[72:75], v12, s[64:67], s73 offen offset:1024 sc1
  buffer_load_dwordx4 v[76:79], v12, s[64:67], s73 offen offset:1536 sc1
  s_add_u32 s73, s73, 4096
  buffer_load_dwordx4 v[80:83], v12, s[64:67], s73 offen offset:0 sc1
  buffer_load_dwordx4 v[84:87], v12, s[64:67], s73 offen offset:512 sc1
  buffer_load_dwordx4 v[88:91], v12, s[64:67], s73 offen offset:1024 sc1
  buffer_load_dwordx4 v[92:95], v12, s[64:67], s73 offen offset:1536 sc1
  s_add_u32 s73, s73, 4096
  buffer_load_dwordx4 v[96:99], v12, s[64:67], s73 offen offset:0 sc1
  buffer_load_dwordx4 v[100:103], v12, s[64:67], s73 offen offset:512 sc1
  buffer_load_dwordx4 v[104:107], v12, s[64:67], s73 offen offset:1024 sc1
  buffer_load_dwordx4 v[108:111], v12, s[64:67], s73 offen offset:1536 sc1
  s_add_u32 s73, s73, 4096
  buffer_load_dwordx4 v[112:115], v12, s[64:67], s73 offen offset:0 sc1
  buffer_load_dwordx4 v[116:119], v12, s[64:67], s73 offen offset:512 sc1
  buffer_load_dwordx4 v[120:123], v12, s[64:67], s73 offen offset:1024 sc1
  buffer_load_dwordx4 v[124:127], v12, s[64:67], s73 offen offset:1536 sc1
Lw_6:
  s_waitcnt vmcnt(5)
  buffer_load_dwordx4 v[200:203], v2, s[28:31], s89 offen offset:512 nt
  s_waitcnt vmcnt(5)
  buffer_load_dwordx4 v[204:207], v2, s[28:31], s89 offen offset:640 nt
  s_waitcnt vmcnt(5)
  s_add_u32 s89, s3, 5
  s_and_b32 s89, s89, 15
  s_lshl_b32 s89, s89, 20
  s_add_u32 s89, s89, s72
  buffer_load_dwordx4 v[208:211], v2, s[28:31], s89 offen offset:0 nt
  s_waitcnt vmcnt(5)
  buffer_load_dwordx4 v[212:215], v2, s[28:31], s89 offen offset:128 nt
  s_waitcnt vmcnt(5)
  buffer_load_dwordx4 v[216:219], v2, s[28:31], s89 offen offset:512 nt
  s_waitcnt vmcnt(5)
  buffer_load_dwordx4 v[220:223], v2, s[28:31], s89 offen offset:640 nt
  s_waitcnt vmcnt(5)
  s_add_u32 s89, s3, 6
  s_and_b32 s89, s89, 15
  s_lshl_b32 s89, s89, 20
  s_add_u32 s89, s89, s72
  buffer_load_dwordx4 v[224:227], v2, s[28:31], s89 offen offset:0 nt
  s_cmp_lg_u32 s68, 1
  s_cbranch_scc1 Lw_7
  s_mov_b32 s94, 0
Lqc_10:
  v_xor_b32 v24, s71, v65
  v_xor_b32 v25, s71, v67
  v_or_b32 v24, v24, v25
  v_xor_b32 v25, s71, v69
  v_or_b32 v24, v24, v25
  v_xor_b32 v25, s71, v71
  v_or_b32 v24, v24, v25
  v_xor_b32 v25, s71, v73
  v_or_b32 v24, v24, v25
  v_xor_b32 v25, s71, v75
  v_or_b32 v24, v24, v25
  v_xor_b32 v25, s71, v77
  v_or_b32 v24, v24, v25
  v_xor_b32 v25, s71, v79
  v_or_b32 v24, v24, v25
  v_xor_b32 v25, s71, v81
  v_or_b32 v24, v24, v25
  v_xor_b32 v25, s71, v83
  v_or_b32 v24, v24, v25
  v_xor_b32 v25, s71, v85
  v_or_b32 v24, v24, v25
  v_xor_b32 v25, s71, v87
  v_or_b32 v24, v24, v25
  v_xor_b32 v25, s71, v89
  v_or_b32 v24, v24, v25
  v_xor_b32 v25, s71, v91
  v_or_b32 v24, v24, v25
  v_xor_b32 v25, s71, v93
  v_or_b32 v24, v24, v25
  v_xor_b32 v25, s71, v95
  v_or_b32 v24, v24, v25
  v_xor_b32 v25, s71, v97
  v_or_b32 v24, v24, v25
  v_xor_b32 v25, s71, v99
  v_or_b32 v24, v24, v25
  v_xor_b32 v25, s71, v101
  v_or_b32 v24, v24, v25
  v_xor_b32 v25, s71, v103
  v_or_b32 v24, v24, v25
  v_xor_b32 v25, s71, v105
  v_or_b32 v24, v24, v25
  v_xor_b32 v25, s71, v107
  v_or_b32 v24, v24, v25
  v_xor_b32 v25, s71, v109
  v_or_b32 v24, v24, v25
  v_xor_b32 v25, s71, v111
  v_or_b32 v24, v24, v25
  v_xor_b32 v25, s71, v113
  v_or_b32 v24, v24, v25
  v_xor_b32 v25, s71, v115
  v_or_b32 v24, v24, v25
  v_xor_b32 v25, s71, v117
  v_or_b32 v24, v24, v25
  v_xor_b32 v25, s71, v119
  v_or_b32 v24, v24, v25
  v_xor_b32 v25, s71, v121
  v_or_b32 v24, v24, v25
  v_xor_b32 v25, s71, v123
  v_or_b32 v24, v24, v25
  v_xor_b32 v25, s71, v125
  v_or_b32 v24, v24, v25
  v_xor_b32 v25, s71, v127
  v_or_b32 v24, v24, v25
  v_cmp_ne_u32 vcc, 0, v24
  s_cmp_lg_u64 vcc, 0
  s_cbranch_scc1 Lqr_8
  s_branch Lqok_9
Lqr_8:
  s_add_u32 s94, s94, 1
  s_cmp_gt_u32 s94, 262144
  s_cbranch_scc1 L_end
  s_lshl_b32 s73, s69, 14
  s_add_u32 s73, s73, 2228224
  buffer_load_dwordx4 v[64:67], v12, s[64:67], s73 offen offset:0 sc1
  buffer_load_dwordx4 v[68:71], v12, s[64:67], s73 offen offset:512 sc1
  buffer_load_dwordx4 v[72:75], v12, s[64:67], s73 offen offset:1024 sc1
  buffer_load_dwordx4 v[76:79], v12, s[64:67], s73 offen offset:1536 sc1
  s_add_u32 s73, s73, 4096
  buffer_load_dwordx4 v[80:83], v12, s[64:67], s73 offen offset:0 sc1
  buffer_load_dwordx4 v[84:87], v12, s[64:67], s73 offen offset:512 sc1
  buffer_load_dwordx4 v[88:91], v12, s[64:67], s73 offen offset:1024 sc1
  buffer_load_dwordx4 v[92:95], v12, s[64:67], s73 offen offset:1536 sc1
  s_add_u32 s73, s73, 4096
  buffer_load_dwordx4 v[96:99], v12, s[64:67], s73 offen offset:0 sc1
  buffer_load_dwordx4 v[100:103], v12, s[64:67], s73 offen offset:512 sc1
  buffer_load_dwordx4 v[104:107], v12, s[64:67], s73 offen offset:1024 sc1
  buffer_load_dwordx4 v[108:111], v12, s[64:67], s73 offen offset:1536 sc1
  s_add_u32 s73, s73, 4096
  buffer_load_dwordx4 v[112:115], v12, s[64:67], s73 offen offset:0 sc1
  buffer_load_dwordx4 v[116:119], v12, s[64:67], s73 offen offset:512 sc1
  buffer_load_dwordx4 v[120:123], v12, s[64:67], s73 offen offset:1024 sc1
  buffer_load_dwordx4 v[124:127], v12, s[64:67], s73 offen offset:1536 sc1
  s_waitcnt vmcnt(0)
  s_branch Lqc_10
Lqok_9:
  v_add_f32 v64, v64, v68
  v_add_f32 v72, v72, v76
  v_add_f32 v66, v66, v70
  v_add_f32 v74, v74, v78
  v_add_f32 v80, v80, v84
  v_add_f32 v88, v88, v92
  v_add_f32 v82, v82, v86
  v_add_f32 v90, v90, v94
  v_add_f32 v96, v96, v100
  v_add_f32 v104, v104, v108
  v_add_f32 v98, v98, v102
  v_add_f32 v106, v106, v110
  v_add_f32 v112, v112, v116
  v_add_f32 v120, v120, v124
  v_add_f32 v114, v114, v118
  v_add_f32 v122, v122, v126
  v_add_f32 v64, v64, v72
  v_add_f32 v66, v66, v74
  v_add_f32 v80, v80, v88
  v_add_f32 v82, v82, v90
  v_add_f32 v96, v96, v104
  v_add_f32 v98, v98, v106
  v_add_f32 v112, v112, v120
  v_add_f32 v114, v114, v122
  v_cvt_pk_bf16_f32 v24, v64, v66
  v_cvt_pk_bf16_f32 v25, v80, v82
  v_cvt_pk_bf16_f32 v26, v96, v98
  v_cvt_pk_bf16_f32 v27, v112, v114
  ds_write_b32 v13, v24 offset:8192
  ds_write_b32 v13, v25 offset:8448
  ds_write_b32 v13, v26 offset:8704
  ds_write_b32 v13, v27 offset:8960
  s_waitcnt lgkmcnt(0)
Lw_7:
  s_barrier
  v_and_b32 v21, 3, v1
  v_lshlrev_b32 v21, 8, v21
  v_lshrrev_b32 v22, 4, v1
  v_lshl_add_u32 v21, v22, 5, v21
  v_bfe_u32 v22, v1, 2, 1
  v_lshl_add_u32 v21, v22, 4, v21
  ds_read_b128 v[56:59], v21 offset:8192
  ds_read_b128 v[60:63], v21 offset:8320
  s_waitcnt lgkmcnt(0)
  s_waitcnt vmcnt(5)
  buffer_load_dwordx4 v[228:231], v2, s[28:31], s89 offen offset:128 nt
  v_mfma_f32_16x16x32_bf16 v[16:19], v[128:131], v[56:59], 0
  v_mfma_f32_16x16x32_bf16 v[20:23], v[136:139], v[56:59], 0
  v_mfma_f32_16x16x32_bf16 v[16:19], v[132:135], v[60:63], v[16:19]
  v_mfma_f32_16x16x32_bf16 v[20:23], v[140:143], v[60:63], v[20:23]
  s_nop 7
  v_permlane32_swap_b32 v16, v20
  v_permlane32_swap_b32 v17, v21
  v_permlane32_swap_b32 v18, v22
  v_permlane32_swap_b32 v19, v23
  v_add_f32_dpp v24, v20, v16 row_shl:4 row_mask:0xf bank_mask:0xf bound_ctrl:0
  v_add_f32_dpp v25, v21, v17 row_shl:4 row_mask:0xf bank_mask:0xf bound_ctrl:0
  v_add_f32_dpp v26, v22, v18 row_shl:4 row_mask:0xf bank_mask:0xf bound_ctrl:0
  v_add_f32_dpp v27, v23, v19 row_shl:4 row_mask:0xf bank_mask:0xf bound_ctrl:0
  v_max3_f32 v4, v24, v25, v4
  v_max3_f32 v4, v26, v27, v4
  v_cvt_pk_bf16_f32 v28, v24, v25
  v_cvt_pk_bf16_f32 v29, v26, v27
  v_lshlrev_b32 v24, 16, v28
  v_and_b32 v25, s78, v28
  v_lshlrev_b32 v26, 16, v29
  v_and_b32 v27, s78, v29
  v_mul_f32 v24, s76, v24
  v_mul_f32 v25, s76, v25
  v_mul_f32 v26, s76, v26
  v_mul_f32 v27, s76, v27
  v_cvt_pk_bf16_f32 v64, v24, v25
  v_cvt_pk_bf16_f32 v65, v26, v27
  s_waitcnt vmcnt(5)
  buffer_load_dwordx4 v[232:235], v2, s[28:31], s89 offen offset:512 nt
  v_mfma_f32_16x16x32_bf16 v[16:19], v[144:147], v[56:59], 0
  v_mfma_f32_16x16x32_bf16 v[20:23], v[152:155], v[56:59], 0
  v_mfma_f32_16x16x32_bf16 v[16:19], v[148:151], v[60:63], v[16:19]
  v_mfma_f32_16x16x32_bf16 v[20:23], v[156:159], v[60:63], v[20:23]
  s_nop 7
  v_permlane32_swap_b32 v16, v20
  v_permlane32_swap_b32 v17, v21
  v_permlane32_swap_b32 v18, v22
  v_permlane32_swap_b32 v19, v23
  v_add_f32_dpp v24, v20, v16 row_shl:4 row_mask:0xf bank_mask:0xf bound_ctrl:0
  v_add_f32_dpp v25, v21, v17 row_shl:4 row_mask:0xf bank_mask:0xf bound_ctrl:0
  v_add_f32_dpp v26, v22, v18 row_shl:4 row_mask:0xf bank_mask:0xf bound_ctrl:0
  v_add_f32_dpp v27, v23, v19 row_shl:4 row_mask:0xf bank_mask:0xf bound_ctrl:0
  v_max3_f32 v4, v24, v25, v4
  v_max3_f32 v4, v26, v27, v4
  v_cvt_pk_bf16_f32 v28, v24, v25
  v_cvt_pk_bf16_f32 v29, v26, v27
  v_lshlrev_b32 v24, 16, v28
  v_and_b32 v25, s78, v28
  v_lshlrev_b32 v26, 16, v29
  v_and_b32 v27, s78, v29
  v_mul_f32 v24, s76, v24
  v_mul_f32 v25, s76, v25
  v_mul_f32 v26, s76, v26
  v_mul_f32 v27, s76, v27
  v_cvt_pk_bf16_f32 v66, v24, v25
  v_cvt_pk_bf16_f32 v67, v26, v27
  s_waitcnt vmcnt(5)
  buffer_load_dwordx4 v[236:239], v2, s[28:31], s89 offen offset:640 nt
  v_mfma_f32_16x16x32_bf16 v[16:19], v[160:163], v[56:59], 0
  v_mfma_f32_16x16x32_bf16 v[20:23], v[168:171], v[56:59], 0
  v_mfma_f32_16x16x32_bf16 v[16:19], v[164:167], v[60:63], v[16:19]
  v_mfma_f32_16x16x32_bf16 v[20:23], v[172:175], v[60:63], v[20:23]
  s_nop 7
  v_permlane32_swap_b32 v16, v20
  v_permlane32_swap_b32 v17, v21
  v_permlane32_swap_b32 v18, v22
  v_permlane32_swap_b32 v19, v23
  v_add_f32_dpp v24, v20, v16 row_shl:4 row_mask:0xf bank_mask:0xf bound_ctrl:0
  v_add_f32_dpp v25, v21, v17 row_shl:4 row_mask:0xf bank_mask:0xf bound_ctrl:0
  v_add_f32_dpp v26, v22, v18 row_shl:4 row_mask:0xf bank_mask:0xf bound_ctrl:0
  v_add_f32_dpp v27, v23, v19 row_shl:4 row_mask:0xf bank_mask:0xf bound_ctrl:0
  v_max3_f32 v4, v24, v25, v4
  v_max3_f32 v4, v26, v27, v4
  v_cvt_pk_bf16_f32 v28, v24, v25
  v_cvt_pk_bf16_f32 v29, v26, v27
  v_lshlrev_b32 v24, 16, v28
  v_and_b32 v25, s78, v28
  v_lshlrev_b32 v26, 16, v29
  v_and_b32 v27, s78, v29
  v_mul_f32 v24, s76, v24
  v_mul_f32 v25, s76, v25
  v_mul_f32 v26, s76, v26
  v_mul_f32 v27, s76, v27
  v_cvt_pk_bf16_f32 v68, v24, v25
  v_cvt_pk_bf16_f32 v69, v26, v27
  s_waitcnt vmcnt(5)
  s_add_u32 s89, s3, 7
  s_and_b32 s89, s89, 15
  s_lshl_b32 s89, s89, 20
  s_add_u32 s89, s89, s72
  buffer_load_dwordx4 v[240:243], v2, s[28:31], s89 offen offset:0 nt
  v_mfma_f32_16x16x32_bf16 v[16:19], v[176:179], v[56:59], 0
  v_mfma_f32_16x16x32_bf16 v[20:23], v[184:187], v[56:59], 0
  v_mfma_f32_16x16x32_bf16 v[16:19], v[180:183], v[60:63], v[16:19]
  v_mfma_f32_16x16x32_bf16 v[20:23], v[188:191], v[60:63], v[20:23]
  s_nop 7
  v_permlane32_swap_b32 v16, v20
  v_permlane32_swap_b32 v17, v21
  v_permlane32_swap_b32 v18, v22
  v_permlane32_swap_b32 v19, v23
  v_add_f32_dpp v24, v20, v16 row_shl:4 row_mask:0xf bank_mask:0xf bound_ctrl:0
  v_add_f32_dpp v25, v21, v17 row_shl:4 row_mask:0xf bank_mask:0xf bound_ctrl:0
  v_add_f32_dpp v26, v22, v18 row_shl:4 row_mask:0xf bank_mask:0xf bound_ctrl:0
  v_add_f32_dpp v27, v23, v19 row_shl:4 row_mask:0xf bank_mask:0xf bound_ctrl:0
  v_max3_f32 v4, v24, v25, v4
  v_max3_f32 v4, v26, v27, v4
  v_cvt_pk_bf16_f32 v28, v24, v25
  v_cvt_pk_bf16_f32 v29, v26, v27
  v_lshlrev_b32 v24, 16, v28
  v_and_b32 v25, s78, v28
  v_lshlrev_b32 v26, 16, v29
  v_and_b32 v27, s78, v29
  v_mul_f32 v24, s76, v24
  v_mul_f32 v25, s76, v25
  v_mul_f32 v26, s76, v26
  v_mul_f32 v27, s76, v27
  v_cvt_pk_bf16_f32 v70, v24, v25
  v_cvt_pk_bf16_f32 v71, v26, v27
  s_waitcnt vmcnt(5)
  buffer_load_dwordx4 v[244:247], v2, s[28:31], s89 offen offset:128 nt
  v_mfma_f32_16x16x32_bf16 v[16:19], v[192:195], v[56:59], 0
  v_mfma_f32_16x16x32_bf16 v[20:23], v[200:203], v[56:59], 0
  v_mfma_f32_16x16x32_bf16 v[16:19], v[196:199], v[60:63], v[16:19]
  v_mfma_f32_16x16x32_bf16 v[20:23], v[204:207], v[60:63], v[20:23]
  s_nop 7
  v_permlane32_swap_b32 v16, v20
  v_permlane32_swap_b32 v17, v21
  v_permlane32_swap_b32 v18, v22
  v_permlane32_swap_b32 v19, v23
  v_add_f32_dpp v24, v20, v16 row_shl:4 row_mask:0xf bank_mask:0xf bound_ctrl:0
  v_add_f32_dpp v25, v21, v17 row_shl:4 row_mask:0xf bank_mask:0xf bound_ctrl:0
  v_add_f32_dpp v26, v22, v18 row_shl:4 row_mask:0xf bank_mask:0xf bound_ctrl:0
  v_add_f32_dpp v27, v23, v19 row_shl:4 row_mask:0xf bank_mask:0xf bound_ctrl:0
  v_max3_f32 v4, v24, v25, v4
  v_max3_f32 v4, v26, v27, v4
  v_cvt_pk_bf16_f32 v28, v24, v25
  v_cvt_pk_bf16_f32 v29, v26, v27
  v_lshlrev_b32 v24, 16, v28
  v_and_b32 v25, s78, v28
  v_lshlrev_b32 v26, 16, v29
  v_and_b32 v27, s78, v29
  v_mul_f32 v24, s76, v24
  v_mul_f32 v25, s76, v25
  v_mul_f32 v26, s76, v26
  v_mul_f32 v27, s76, v27
  v_cvt_pk_bf16_f32 v72, v24, v25
  v_cvt_pk_bf16_f32 v73, v26, v27
  s_waitcnt vmcnt(5)
  buffer_load_dwordx4 v[248:251], v2, s[28:31], s89 offen offset:512 nt
  v_mfma_f32_16x16x32_bf16 v[16:19], v[208:211], v[56:59], 0
  v_mfma_f32_16x16x32_bf16 v[20:23], v[216:219], v[56:59], 0
  v_mfma_f32_16x16x32_bf16 v[16:19], v[212:215], v[60:63], v[16:19]
  v_mfma_f32_16x16x32_bf16 v[20:23], v[220:223], v[60:63], v[20:23]
  s_nop 7
  v_permlane32_swap_b32 v16, v20
  v_permlane32_swap_b32 v17, v21
  v_permlane32_swap_b32 v18, v22
  v_permlane32_swap_b32 v19, v23
  v_add_f32_dpp v24, v20, v16 row_shl:4 row_mask:0xf bank_mask:0xf bound_ctrl:0
  v_add_f32_dpp v25, v21, v17 row_shl:4 row_mask:0xf bank_mask:0xf bound_ctrl:0
  v_add_f32_dpp v26, v22, v18 row_shl:4 row_mask:0xf bank_mask:0xf bound_ctrl:0
  v_add_f32_dpp v27, v23, v19 row_shl:4 row_mask:0xf bank_mask:0xf bound_ctrl:0
  v_max3_f32 v4, v24, v25, v4
  v_max3_f32 v4, v26, v27, v4
  v_cvt_pk_bf16_f32 v28, v24, v25
  v_cvt_pk_bf16_f32 v29, v26, v27
  v_lshlrev_b32 v24, 16, v28
  v_and_b32 v25, s78, v28
  v_lshlrev_b32 v26, 16, v29
  v_and_b32 v27, s78, v29
  v_mul_f32 v24, s76, v24
  v_mul_f32 v25, s76, v25
  v_mul_f32 v26, s76, v26
  v_mul_f32 v27, s76, v27
  v_cvt_pk_bf16_f32 v74, v24, v25
  v_cvt_pk_bf16_f32 v75, v26, v27
  s_waitcnt vmcnt(5)
  buffer_load_dwordx4 v[252:255], v2, s[28:31], s89 offen offset:640 nt
  s_waitcnt vmcnt(5)
  s_add_u32 s89, s3, 8
  s_and_b32 s89, s89, 15
  s_lshl_b32 s89, s89, 20
  s_add_u32 s89, s89, s72
  buffer_load_dwordx4 v[128:131], v2, s[28:31], s89 offen offset:0 nt
  s_waitcnt vmcnt(5)
  buffer_load_dwordx4 v[132:135], v2, s[28:31], s89 offen offset:128 nt
  v_mfma_f32_16x16x32_bf16 v[16:19], v[224:227], v[56:59], 0
  v_mfma_f32_16x16x32_bf16 v[20:23], v[232:235], v[56:59], 0
  v_mfma_f32_16x16x32_bf16 v[16:19], v[228:231], v[60:63], v[16:19]
  v_mfma_f32_16x16x32_bf16 v[20:23], v[236:239], v[60:63], v[20:23]
  s_nop 7
  v_permlane32_swap_b32 v16, v20
  v_permlane32_swap_b32 v17, v21
  v_permlane32_swap_b32 v18, v22
  v_permlane32_swap_b32 v19, v23
  v_add_f32_dpp v24, v20, v16 row_shl:4 row_mask:0xf bank_mask:0xf bound_ctrl:0
  v_add_f32_dpp v25, v21, v17 row_shl:4 row_mask:0xf bank_mask:0xf bound_ctrl:0
  v_add_f32_dpp v26, v22, v18 row_shl:4 row_mask:0xf bank_mask:0xf bound_ctrl:0
  v_add_f32_dpp v27, v23, v19 row_shl:4 row_mask:0xf bank_mask:0xf bound_ctrl:0
  v_max3_f32 v4, v24, v25, v4
  v_max3_f32 v4, v26, v27, v4
  v_cvt_pk_bf16_f32 v28, v24, v25
  v_cvt_pk_bf16_f32 v29, v26, v27
  v_lshlrev_b32 v24, 16, v28
  v_and_b32 v25, s78, v28
  v_lshlrev_b32 v26, 16, v29
  v_and_b32 v27, s78, v29
  v_mul_f32 v24, s76, v24
  v_mul_f32 v25, s76, v25
  v_mul_f32 v26, s76, v26
  v_mul_f32 v27, s76, v27
  v_cvt_pk_bf16_f32 v76, v24, v25
  v_cvt_pk_bf16_f32 v77, v26, v27
  s_waitcnt vmcnt(5)
  buffer_load_dwordx4 v[136:139], v2, s[28:31], s89 offen offset:512 nt
  s_waitcnt vmcnt(5)
  buffer_load_dwordx4 v[140:143], v2, s[28:31], s89 offen offset:640 nt
  s_waitcnt vmcnt(5)
  s_add_u32 s89, s3, 9
  s_and_b32 s89, s89, 15
  s_lshl_b32 s89, s89, 20
  s_add_u32 s89, s89, s72
  buffer_load_dwordx4 v[144:147], v2, s[28:31], s89 offen offset:0 nt
  s_waitcnt vmcnt(5)
  buffer_load_dwordx4 v[148:151], v2, s[28:31], s89 offen offset:128 nt
  v_mfma_f32_16x16x32_bf16 v[16:19], v[240:243], v[56:59], 0
  v_mfma_f32_16x16x32_bf16 v[20:23], v[248:251], v[56:59], 0
  v_mfma_f32_16x16x32_bf16 v[16:19], v[244:247], v[60:63], v[16:19]
  v_mfma_f32_16x16x32_bf16 v[20:23], v[252:255], v[60:63], v[20:23]
  s_nop 7
  v_permlane32_swap_b32 v16, v20
  v_permlane32_swap_b32 v17, v21
  v_permlane32_swap_b32 v18, v22
  v_permlane32_swap_b32 v19, v23
  v_add_f32_dpp v24, v20, v16 row_shl:4 row_mask:0xf bank_mask:0xf bound_ctrl:0
  v_add_f32_dpp v25, v21, v17 row_shl:4 row_mask:0xf bank_mask:0xf bound_ctrl:0
  v_add_f32_dpp v26, v22, v18 row_shl:4 row_mask:0xf bank_mask:0xf bound_ctrl:0
  v_add_f32_dpp v27, v23, v19 row_shl:4 row_mask:0xf bank_mask:0xf bound_ctrl:0
  v_max3_f32 v4, v24, v25, v4
  v_max3_f32 v4, v26, v27, v4
  v_cvt_pk_bf16_f32 v28, v24, v25
  v_cvt_pk_bf16_f32 v29, v26, v27
  v_lshlrev_b32 v24, 16, v28
  v_and_b32 v25, s78, v28
  v_lshlrev_b32 v26, 16, v29
  v_and_b32 v27, s78, v29
  v_mul_f32 v24, s76, v24
  v_mul_f32 v25, s76, v25
  v_mul_f32 v26, s76, v26
  v_mul_f32 v27, s76, v27
  v_cvt_pk_bf16_f32 v78, v24, v25
  v_cvt_pk_bf16_f32 v79, v26, v27
  s_waitcnt vmcnt(5)
  buffer_load_dwordx4 v[152:155], v2, s[28:31], s89 offen offset:512 nt
  s_waitcnt vmcnt(5)
  buffer_load_dwordx4 v[156:159], v2, s[28:31], s89 offen offset:640 nt
  s_waitcnt vmcnt(5)
  s_add_u32 s89, s3, 10
  s_and_b32 s89, s89, 15
  s_lshl_b32 s89, s89, 20
  s_add_u32 s89, s89, s72
  buffer_load_dwordx4 v[160:163], v2, s[28:31], s89 offen offset:0 nt
  s_waitcnt vmcnt(5)
  buffer_load_dwordx4 v[164:167], v2, s[28:31], s89 offen offset:128 nt
  v_mfma_f32_16x16x32_bf16 v[16:19], v[128:131], v[56:59], 0
  v_mfma_f32_16x16x32_bf16 v[20:23], v[136:139], v[56:59], 0
  v_mfma_f32_16x16x32_bf16 v[16:19], v[132:135], v[60:63], v[16:19]
  v_mfma_f32_16x16x32_bf16 v[20:23], v[140:143], v[60:63], v[20:23]
  s_nop 7
  v_permlane32_swap_b32 v16, v20
  v_permlane32_swap_b32 v17, v21
  v_permlane32_swap_b32 v18, v22
  v_permlane32_swap_b32 v19, v23
  v_add_f32_dpp v24, v20, v16 row_shl:4 row_mask:0xf bank_mask:0xf bound_ctrl:0
  v_add_f32_dpp v25, v21, v17 row_shl:4 row_mask:0xf bank_mask:0xf bound_ctrl:0
  v_add_f32_dpp v26, v22, v18 row_shl:4 row_mask:0xf bank_mask:0xf bound_ctrl:0
  v_add_f32_dpp v27, v23, v19 row_shl:4 row_mask:0xf bank_mask:0xf bound_ctrl:0
  v_max3_f32 v4, v24, v25, v4
  v_max3_f32 v4, v26, v27, v4
  v_cvt_pk_bf16_f32 v28, v24, v25
  v_cvt_pk_bf16_f32 v29, v26, v27
  v_lshlrev_b32 v24, 16, v28
  v_and_b32 v25, s78, v28
  v_lshlrev_b32 v26, 16, v29
  v_and_b32 v27, s78, v29
  v_mul_f32 v24, s76, v24
  v_mul_f32 v25, s76, v25
  v_mul_f32 v26, s76, v26
  v_mul_f32 v27, s76, v27
  v_cvt_pk_bf16_f32 v80, v24, v25
  v_cvt_pk_bf16_f32 v81, v26, v27
  s_waitcnt vmcnt(5)
  buffer_load_dwordx4 v[168:171], v2, s[28:31], s89 offen offset:512 nt
  s_waitcnt vmcnt(5)
  buffer_load_dwordx4 v[172:175], v2, s[28:31], s89 offen offset:640 nt
  s_waitcnt vmcnt(5)
  s_add_u32 s89, s3, 11
  s_and_b32 s89, s89, 15
  s_lshl_b32 s89, s89, 20
  s_add_u32 s89, s89, s72
  buffer_load_dwordx4 v[176:179], v2, s[28:31], s89 offen offset:0 nt
  s_waitcnt vmcnt(5)
  buffer_load_dwordx4 v[180:183], v2, s[28:31], s89 offen offset:128 nt
  v_mfma_f32_16x16x32_bf16 v[16:19], v[144:147], v[56:59], 0
  v_mfma_f32_16x16x32_bf16 v[20:23], v[152:155], v[56:59], 0
  v_mfma_f32_16x16x32_bf16 v[16:19], v[148:151], v[60:63], v[16:19]
  v_mfma_f32_16x16x32_bf16 v[20:23], v[156:159], v[60:63], v[20:23]
  s_nop 7
  v_permlane32_swap_b32 v16, v20
  v_permlane32_swap_b32 v17, v21
  v_permlane32_swap_b32 v18, v22
  v_permlane32_swap_b32 v19, v23
  v_add_f32_dpp v24, v20, v16 row_shl:4 row_mask:0xf bank_mask:0xf bound_ctrl:0
  v_add_f32_dpp v25, v21, v17 row_shl:4 row_mask:0xf bank_mask:0xf bound_ctrl:0
  v_add_f32_dpp v26, v22, v18 row_shl:4 row_mask:0xf bank_mask:0xf bound_ctrl:0
  v_add_f32_dpp v27, v23, v19 row_shl:4 row_mask:0xf bank_mask:0xf bound_ctrl:0
  v_max3_f32 v4, v24, v25, v4
  v_max3_f32 v4, v26, v27, v4
  v_cvt_pk_bf16_f32 v28, v24, v25
  v_cvt_pk_bf16_f32 v29, v26, v27
  v_lshlrev_b32 v24, 16, v28
  v_and_b32 v25, s78, v28
  v_lshlrev_b32 v26, 16, v29
  v_and_b32 v27, s78, v29
  v_mul_f32 v24, s76, v24
  v_mul_f32 v25, s76, v25
  v_mul_f32 v26, s76, v26
  v_mul_f32 v27, s76, v27
  v_cvt_pk_bf16_f32 v82, v24, v25
  v_cvt_pk_bf16_f32 v83, v26, v27
  s_waitcnt vmcnt(5)
  buffer_load_dwordx4 v[184:187], v2, s[28:31], s89 offen offset:512 nt
  s_waitcnt vmcnt(5)
  buffer_load_dwordx4 v[188:191], v2, s[28:31], s89 offen offset:640 nt
  s_waitcnt vmcnt(5)
  s_add_u32 s89, s3, 12
  s_and_b32 s89, s89, 15
  s_lshl_b32 s89, s89, 20
  s_add_u32 s89, s89, s72
  buffer_load_dwordx4 v[192:195], v2, s[28:31], s89 offen offset:0 nt
  s_waitcnt vmcnt(5)
  buffer_load_dwordx4 v[196:199], v2, s[28:31], s89 offen offset:128 nt
  v_mfma_f32_16x16x32_bf16 v[16:19], v[160:163], v[56:59], 0
  v_mfma_f32_16x16x32_bf16 v[20:23], v[168:171], v[56:59], 0
  v_mfma_f32_16x16x32_bf16 v[16:19], v[164:167], v[60:63], v[16:19]
  v_mfma_f32_16x16x32_bf16 v[20:23], v[172:175], v[60:63], v[20:23]
  s_nop 7
  v_permlane32_swap_b32 v16, v20
  v_permlane32_swap_b32 v17, v21
  v_permlane32_swap_b32 v18, v22
  v_permlane32_swap_b32 v19, v23
  v_add_f32_dpp v24, v20, v16 row_shl:4 row_mask:0xf bank_mask:0xf bound_ctrl:0
  v_add_f32_dpp v25, v21, v17 row_shl:4 row_mask:0xf bank_mask:0xf bound_ctrl:0
  v_add_f32_dpp v26, v22, v18 row_shl:4 row_mask:0xf bank_mask:0xf bound_ctrl:0
  v_add_f32_dpp v27, v23, v19 row_shl:4 row_mask:0xf bank_mask:0xf bound_ctrl:0
  v_max3_f32 v4, v24, v25, v4
  v_max3_f32 v4, v26, v27, v4
  v_cvt_pk_bf16_f32 v28, v24, v25
  v_cvt_pk_bf16_f32 v29, v26, v27
  v_lshlrev_b32 v24, 16, v28
  v_and_b32 v25, s78, v28
  v_lshlrev_b32 v26, 16, v29
  v_and_b32 v27, s78, v29
  v_mul_f32 v24, s76, v24
  v_mul_f32 v25, s76, v25
  v_mul_f32 v26, s76, v26
  v_mul_f32 v27, s76, v27
  v_cvt_pk_bf16_f32 v84, v24, v25
  v_cvt_pk_bf16_f32 v85, v26, v27
  s_waitcnt vmcnt(5)
  buffer_load_dwordx4 v[200:203], v2, s[28:31], s89 offen offset:512 nt
  s_waitcnt vmcnt(5)
  buffer_load_dwordx4 v[204:207], v2, s[28:31], s89 offen offset:640 nt
  s_waitcnt vmcnt(5)
  s_add_u32 s89, s3, 13
  s_and_b32 s89, s89, 15
  s_lshl_b32 s89, s89, 20
  s_add_u32 s89, s89, s72
  buffer_load_dwordx4 v[208:211], v2, s[28:31], s89 offen offset:0 nt
  s_waitcnt vmcnt(5)
  buffer_load_dwordx4 v[212:215], v2, s[28:31], s89 offen offset:128 nt
  v_mfma_f32_16x16x32_bf16 v[16:19], v[176:179], v[56:59], 0
  v_mfma_f32_16x16x32_bf16 v[20:23], v[184:187], v[56:59], 0
  v_mfma_f32_16x16x32_bf16 v[16:19], v[180:183], v[60:63], v[16:19]
  v_mfma_f32_16x16x32_bf16 v[20:23], v[188:191], v[60:63], v[20:23]
  s_nop 7
  v_permlane32_swap_b32 v16, v20
  v_permlane32_swap_b32 v17, v21
  v_permlane32_swap_b32 v18, v22
  v_permlane32_swap_b32 v19, v23
  v_add_f32_dpp v24, v20, v16 row_shl:4 row_mask:0xf bank_mask:0xf bound_ctrl:0
  v_add_f32_dpp v25, v21, v17 row_shl:4 row_mask:0xf bank_mask:0xf bound_ctrl:0
  v_add_f32_dpp v26, v22, v18 row_shl:4 row_mask:0xf bank_mask:0xf bound_ctrl:0
  v_add_f32_dpp v27, v23, v19 row_shl:4 row_mask:0xf bank_mask:0xf bound_ctrl:0
  v_max3_f32 v4, v24, v25, v4
  v_max3_f32 v4, v26, v27, v4
  v_cvt_pk_bf16_f32 v28, v24, v25
  v_cvt_pk_bf16_f32 v29, v26, v27
  v_lshlrev_b32 v24, 16, v28
  v_and_b32 v25, s78, v28
  v_lshlrev_b32 v26, 16, v29
  v_and_b32 v27, s78, v29
  v_mul_f32 v24, s76, v24
  v_mul_f32 v25, s76, v25
  v_mul_f32 v26, s76, v26
  v_mul_f32 v27, s76, v27
  v_cvt_pk_bf16_f32 v86, v24, v25
  v_cvt_pk_bf16_f32 v87, v26, v27
  s_waitcnt vmcnt(5)
  buffer_load_dwordx4 v[216:219], v2, s[28:31], s89 offen offset:512 nt
  s_waitcnt vmcnt(5)
  buffer_load_dwordx4 v[220:223], v2, s[28:31], s89 offen offset:640 nt
  s_waitcnt vmcnt(5)
  s_add_u32 s89, s3, 14
  s_and_b32 s89, s89, 15
  s_lshl_b32 s89, s89, 20
  s_add_u32 s89, s89, s72
  buffer_load_dwordx4 v[224:227], v2, s[28:31], s89 offen offset:0 nt
  s_waitcnt vmcnt(5)
  buffer_load_dwordx4 v[228:231], v2, s[28:31], s89 offen offset:128 nt
  v_mfma_f32_16x16x32_bf16 v[16:19], v[192:195], v[56:59], 0
  v_mfma_f32_16x16x32_bf16 v[20:23], v[200:203], v[56:59], 0
  v_mfma_f32_16x16x32_bf16 v[16:19], v[196:199], v[60:63], v[16:19]
  v_mfma_f32_16x16x32_bf16 v[20:23], v[204:207], v[60:63], v[20:23]
  s_nop 7
  v_permlane32_swap_b32 v16, v20
  v_permlane32_swap_b32 v17, v21
  v_permlane32_swap_b32 v18, v22
  v_permlane32_swap_b32 v19, v23
  v_add_f32_dpp v24, v20, v16 row_shl:4 row_mask:0xf bank_mask:0xf bound_ctrl:0
  v_add_f32_dpp v25, v21, v17 row_shl:4 row_mask:0xf bank_mask:0xf bound_ctrl:0
  v_add_f32_dpp v26, v22, v18 row_shl:4 row_mask:0xf bank_mask:0xf bound_ctrl:0
  v_add_f32_dpp v27, v23, v19 row_shl:4 row_mask:0xf bank_mask:0xf bound_ctrl:0
  v_max3_f32 v4, v24, v25, v4
  v_max3_f32 v4, v26, v27, v4
  v_cvt_pk_bf16_f32 v28, v24, v25
  v_cvt_pk_bf16_f32 v29, v26, v27
  v_lshlrev_b32 v24, 16, v28
  v_and_b32 v25, s78, v28
  v_lshlrev_b32 v26, 16, v29
  v_and_b32 v27, s78, v29
  v_mul_f32 v24, s76, v24
  v_mul_f32 v25, s76, v25
  v_mul_f32 v26, s76, v26
  v_mul_f32 v27, s76, v27
  v_cvt_pk_bf16_f32 v88, v24, v25
  v_cvt_pk_bf16_f32 v89, v26, v27
  s_waitcnt vmcnt(5)
  buffer_load_dwordx4 v[232:235], v2, s[28:31], s89 offen offset:512 nt
  s_waitcnt vmcnt(5)
  buffer_load_dwordx4 v[236:239], v2, s[28:31], s89 offen offset:640 nt
  s_waitcnt vmcnt(5)
  s_add_u32 s89, s3, 15
  s_and_b32 s89, s89, 15
  s_lshl_b32 s89, s89, 20
  s_add_u32 s89, s89, s72
  buffer_load_dwordx4 v[240:243], v2, s[28:31], s89 offen offset:0 nt
  s_waitcnt vmcnt(5)
  buffer_load_dwordx4 v[244:247], v2, s[28:31], s89 offen offset:128 nt
  v_mfma_f32_16x16x32_bf16 v[16:19], v[208:211], v[56:59], 0
  v_mfma_f32_16x16x32_bf16 v[20:23], v[216:219], v[56:59], 0
  v_mfma_f32_16x16x32_bf16 v[16:19], v[212:215], v[60:63], v[16:19]
  v_mfma_f32_16x16x32_bf16 v[20:23], v[220:223], v[60:63], v[20:23]
  s_nop 7
  v_permlane32_swap_b32 v16, v20
  v_permlane32_swap_b32 v17, v21
  v_permlane32_swap_b32 v18, v22
  v_permlane32_swap_b32 v19, v23
  v_add_f32_dpp v24, v20, v16 row_shl:4 row_mask:0xf bank_mask:0xf bound_ctrl:0
  v_add_f32_dpp v25, v21, v17 row_shl:4 row_mask:0xf bank_mask:0xf bound_ctrl:0
  v_add_f32_dpp v26, v22, v18 row_shl:4 row_mask:0xf bank_mask:0xf bound_ctrl:0
  v_add_f32_dpp v27, v23, v19 row_shl:4 row_mask:0xf bank_mask:0xf bound_ctrl:0
  v_max3_f32 v4, v24, v25, v4
  v_max3_f32 v4, v26, v27, v4
  v_cvt_pk_bf16_f32 v28, v24, v25
  v_cvt_pk_bf16_f32 v29, v26, v27
  v_lshlrev_b32 v24, 16, v28
  v_and_b32 v25, s78, v28
  v_lshlrev_b32 v26, 16, v29
  v_and_b32 v27, s78, v29
  v_mul_f32 v24, s76, v24
  v_mul_f32 v25, s76, v25
  v_mul_f32 v26, s76, v26
  v_mul_f32 v27, s76, v27
  v_cvt_pk_bf16_f32 v90, v24, v25
  v_cvt_pk_bf16_f32 v91, v26, v27
  s_waitcnt vmcnt(5)
  buffer_load_dwordx4 v[248:251], v2, s[28:31], s89 offen offset:512 nt
  s_waitcnt vmcnt(5)
  buffer_load_dwordx4 v[252:255], v2, s[28:31], s89 offen offset:640 nt
  s_waitcnt vmcnt(5)
  s_add_u32 s89, s3, 0
  s_and_b32 s89, s89, 15
  s_lshl_b32 s89, s89, 20
  s_add_u32 s89, s89, s72
  buffer_load_dwordx4 v[128:131], v3, s[32:35], s89 offen offset:0 nt
  s_waitcnt vmcnt(5)
  buffer_load_dwordx4 v[132:135], v3, s[32:35], s89 offen offset:1024 nt
  v_mfma_f32_16x16x32_bf16 v[16:19], v[224:227], v[56:59], 0
  v_mfma_f32_16x16x32_bf16 v[20:23], v[232:235], v[56:59], 0
  v_mfma_f32_16x16x32_bf16 v[16:19], v[228:231], v[60:63], v[16:19]
  v_mfma_f32_16x16x32_bf16 v[20:23], v[236:239], v[60:63], v[20:23]
  s_nop 7
  v_permlane32_swap_b32 v16, v20
  v_permlane32_swap_b32 v17, v21
  v_permlane32_swap_b32 v18, v22
  v_permlane32_swap_b32 v19, v23
  v_add_f32_dpp v24, v20, v16 row_shl:4 row_mask:0xf bank_mask:0xf bound_ctrl:0
  v_add_f32_dpp v25, v21, v17 row_shl:4 row_mask:0xf bank_mask:0xf bound_ctrl:0
  v_add_f32_dpp v26, v22, v18 row_shl:4 row_mask:0xf bank_mask:0xf bound_ctrl:0
  v_add_f32_dpp v27, v23, v19 row_shl:4 row_mask:0xf bank_mask:0xf bound_ctrl:0
  v_max3_f32 v4, v24, v25, v4
  v_max3_f32 v4, v26, v27, v4
  v_cvt_pk_bf16_f32 v28, v24, v25
  v_cvt_pk_bf16_f32 v29, v26, v27
  v_lshlrev_b32 v24, 16, v28
  v_and_b32 v25, s78, v28
  v_lshlrev_b32 v26, 16, v29
  v_and_b32 v27, s78, v29
  v_mul_f32 v24, s76, v24
  v_mul_f32 v25, s76, v25
  v_mul_f32 v26, s76, v26
  v_mul_f32 v27, s76, v27
  v_cvt_pk_bf16_f32 v92, v24, v25
  v_cvt_pk_bf16_f32 v93, v26, v27
  s_waitcnt vmcnt(5)
  buffer_load_dwordx4 v[136:139], v3, s[32:35], s89 offen offset:2048 nt
  s_waitcnt vmcnt(5)
  buffer_load_dwordx4 v[140:143], v3, s[32:35], s89 offen offset:3072 nt
  s_waitcnt vmcnt(5)
  s_add_u32 s89, s3, 1
  s_and_b32 s89, s89, 15
  s_lshl_b32 s89, s89, 20
  s_add_u32 s89, s89, s72
  buffer_load_dwordx4 v[144:147], v3, s[32:35], s89 offen offset:0 nt
  s_waitcnt vmcnt(5)
  buffer_load_dwordx4 v[148:151], v3, s[32:35], s89 offen offset:1024 nt
  v_mfma_f32_16x16x32_bf16 v[16:19], v[240:243], v[56:59], 0
  v_mfma_f32_16x16x32_bf16 v[20:23], v[248:251], v[56:59], 0
  v_mfma_f32_16x16x32_bf16 v[16:19], v[244:247], v[60:63], v[16:19]
  v_mfma_f32_16x16x32_bf16 v[20:23], v[252:255], v[60:63], v[20:23]
  s_nop 7
  v_permlane32_swap_b32 v16, v20
  v_permlane32_swap_b32 v17, v21
  v_permlane32_swap_b32 v18, v22
  v_permlane32_swap_b32 v19, v23
  v_add_f32_dpp v24, v20, v16 row_shl:4 row_mask:0xf bank_mask:0xf bound_ctrl:0
  v_add_f32_dpp v25, v21, v17 row_shl:4 row_mask:0xf bank_mask:0xf bound_ctrl:0
  v_add_f32_dpp v26, v22, v18 row_shl:4 row_mask:0xf bank_mask:0xf bound_ctrl:0
  v_add_f32_dpp v27, v23, v19 row_shl:4 row_mask:0xf bank_mask:0xf bound_ctrl:0
  v_max3_f32 v4, v24, v25, v4
  v_max3_f32 v4, v26, v27, v4
  v_cvt_pk_bf16_f32 v28, v24, v25
  v_cvt_pk_bf16_f32 v29, v26, v27
  v_lshlrev_b32 v24, 16, v28
  v_and_b32 v25, s78, v28
  v_lshlrev_b32 v26, 16, v29
  v_and_b32 v27, s78, v29
  v_mul_f32 v24, s76, v24
  v_mul_f32 v25, s76, v25
  v_mul_f32 v26, s76, v26
  v_mul_f32 v27, s76, v27
  v_cvt_pk_bf16_f32 v94, v24, v25
  v_cvt_pk_bf16_f32 v95, v26, v27
  s_waitcnt vmcnt(5)
  buffer_load_dwordx4 v[152:155], v3, s[32:35], s89 offen offset:2048 nt
  v_mov_b32 v24, v4
  s_nop 1
  v_permlane16_swap_b32 v4, v24
  v_max_f32 v4, v4, v24
  v_mov_b32 v24, v4
  s_nop 1
  v_permlane32_swap_b32 v4, v24
  v_max_f32 v4, v4, v24
  v_cvt_pk_bf16_f32 v7, v4, v4
  v_and_b32 v7, s78, v7
  v_mul_f32 v7, s76, v7
  v_cvt_pk_bf16_f32 v7, v7, v7
  v_and_b32 v7, s78, v7
  v_mul_f32 v6, s77, v7
  s_waitcnt vmcnt(5)
  buffer_load_dwordx4 v[156:159], v3, s[32:35], s89 offen offset:3072 nt
  v_lshlrev_b32 v24, 16, v64
  v_and_b32 v25, s78, v64
  v_lshlrev_b32 v26, 16, v65
  v_and_b32 v27, s78, v65
  v_lshlrev_b32 v28, 16, v66
  v_and_b32 v29, s78, v66
  v_lshlrev_b32 v30, 16, v67
  v_and_b32 v31, s78, v67
  v_fma_f32 v24, v24, s77, -v6
  v_fma_f32 v25, v25, s77, -v6
  v_fma_f32 v26, v26, s77, -v6
  v_fma_f32 v27, v27, s77, -v6
  v_fma_f32 v28, v28, s77, -v6
  v_fma_f32 v29, v29, s77, -v6
  v_fma_f32 v30, v30, s77, -v6
  v_fma_f32 v31, v31, s77, -v6
  v_exp_f32 v24, v24
  v_exp_f32 v25, v25
  v_exp_f32 v26, v26
  v_exp_f32 v27, v27
  v_exp_f32 v28, v28
  v_exp_f32 v29, v29
  v_exp_f32 v30, v30
  v_exp_f32 v31, v31
  s_nop 0
  v_cvt_pk_bf16_f32 v64, v24, v25
  v_cvt_pk_bf16_f32 v65, v26, v27
  v_cvt_pk_bf16_f32 v66, v28, v29
  v_cvt_pk_bf16_f32 v67, v30, v31
  v_add_f32 v24, v24, v25
  v_add_f32 v26, v26, v27
  v_add_f32 v28, v28, v29
  v_add_f32 v30, v30, v31
  v_add_f32 v24, v24, v26
  v_add_f32 v28, v28, v30
  v_add_f32 v24, v24, v28
  v_add_f32 v5, v5, v24
  s_waitcnt vmcnt(5)
  s_add_u32 s89, s3, 2
  s_and_b32 s89, s89, 15
  s_lshl_b32 s89, s89, 20
  s_add_u32 s89, s89, s72
  buffer_load_dwordx4 v[160:163], v3, s[32:35], s89 offen offset:0 nt
  v_lshlrev_b32 v24, 16, v68
  v_and_b32 v25, s78, v68
  v_lshlrev_b32 v26, 16, v69
  v_and_b32 v27, s78, v69
  v_lshlrev_b32 v28, 16, v70
  v_and_b32 v29, s78, v70
  v_lshlrev_b32 v30, 16, v71
  v_and_b32 v31, s78, v71
  v_fma_f32 v24, v24, s77, -v6
  v_fma_f32 v25, v25, s77, -v6
  v_fma_f32 v26, v26, s77, -v6
  v_fma_f32 v27, v27, s77, -v6
  v_fma_f32 v28, v28, s77, -v6
  v_fma_f32 v29, v29, s77, -v6
  v_fma_f32 v30, v30, s77, -v6
  v_fma_f32 v31, v31, s77, -v6
  v_exp_f32 v24, v24
  v_exp_f32 v25, v25
  v_exp_f32 v26, v26
  v_exp_f32 v27, v27
  v_exp_f32 v28, v28
  v_exp_f32 v29, v29
  v_exp_f32 v30, v30
  v_exp_f32 v31, v31
  s_nop 0
  v_cvt_pk_bf16_f32 v68, v24, v25
  v_cvt_pk_bf16_f32 v69, v26, v27
  v_cvt_pk_bf16_f32 v70, v28, v29
  v_cvt_pk_bf16_f32 v71, v30, v31
  v_add_f32 v24, v24, v25
  v_add_f32 v26, v26, v27
  v_add_f32 v28, v28, v29
  v_add_f32 v30, v30, v31
  v_add_f32 v24, v24, v26
  v_add_f32 v28, v28, v30
  v_add_f32 v24, v24, v28
  v_add_f32 v5, v5, v24
  s_waitcnt vmcnt(5)
  buffer_load_dwordx4 v[164:167], v3, s[32:35], s89 offen offset:1024 nt
  v_lshlrev_b32 v24, 16, v72
  v_and_b32 v25, s78, v72
  v_lshlrev_b32 v26, 16, v73
  v_and_b32 v27, s78, v73
  v_lshlrev_b32 v28, 16, v74
  v_and_b32 v29, s78, v74
  v_lshlrev_b32 v30, 16, v75
  v_and_b32 v31, s78, v75
  v_fma_f32 v24, v24, s77, -v6
  v_fma_f32 v25, v25, s77, -v6
  v_fma_f32 v26, v26, s77, -v6
  v_fma_f32 v27, v27, s77, -v6
  v_fma_f32 v28, v28, s77, -v6
  v_fma_f32 v29, v29, s77, -v6
  v_fma_f32 v30, v30, s77, -v6
  v_fma_f32 v31, v31, s77, -v6
  v_exp_f32 v24, v24
  v_exp_f32 v25, v25
  v_exp_f32 v26, v26
  v_exp_f32 v27, v27
  v_exp_f32 v28, v28
  v_exp_f32 v29, v29
  v_exp_f32 v30, v30
  v_exp_f32 v31, v31
  s_nop 0
  v_cvt_pk_bf16_f32 v72, v24, v25
  v_cvt_pk_bf16_f32 v73, v26, v27
  v_cvt_pk_bf16_f32 v74, v28, v29
  v_cvt_pk_bf16_f32 v75, v30, v31
  v_add_f32 v24, v24, v25
  v_add_f32 v26, v26, v27
  v_add_f32 v28, v28, v29
  v_add_f32 v30, v30, v31
  v_add_f32 v24, v24, v26
  v_add_f32 v28, v28, v30
  v_add_f32 v24, v24, v28
  v_add_f32 v5, v5, v24
  s_waitcnt vmcnt(5)
  buffer_load_dwordx4 v[168:171], v3, s[32:35], s89 offen offset:2048 nt
  v_lshlrev_b32 v24, 16, v76
  v_and_b32 v25, s78, v76
  v_lshlrev_b32 v26, 16, v77
  v_and_b32 v27, s78, v77
  v_lshlrev_b32 v28, 16, v78
  v_and_b32 v29, s78, v78
  v_lshlrev_b32 v30, 16, v79
  v_and_b32 v31, s78, v79
  v_fma_f32 v24, v24, s77, -v6
  v_fma_f32 v25, v25, s77, -v6
  v_fma_f32 v26, v26, s77, -v6
  v_fma_f32 v27, v27, s77, -v6
  v_fma_f32 v28, v28, s77, -v6
  v_fma_f32 v29, v29, s77, -v6
  v_fma_f32 v30, v30, s77, -v6
  v_fma_f32 v31, v31, s77, -v6
  v_exp_f32 v24, v24
  v_exp_f32 v25, v25
  v_exp_f32 v26, v26
  v_exp_f32 v27, v27
  v_exp_f32 v28, v28
  v_exp_f32 v29, v29
  v_exp_f32 v30, v30
  v_exp_f32 v31, v31
  s_nop 0
  v_cvt_pk_bf16_f32 v76, v24, v25
  v_cvt_pk_bf16_f32 v77, v26, v27
  v_cvt_pk_bf16_f32 v78, v28, v29
  v_cvt_pk_bf16_f32 v79, v30, v31
  v_add_f32 v24, v24, v25
  v_add_f32 v26, v26, v27
  v_add_f32 v28, v28, v29
  v_add_f32 v30, v30, v31
  v_add_f32 v24, v24, v26
  v_add_f32 v28, v28, v30
  v_add_f32 v24, v24, v28
  v_add_f32 v5, v5, v24
  s_waitcnt vmcnt(5)
  buffer_load_dwordx4 v[172:175], v3, s[32:35], s89 offen offset:3072 nt
  v_lshlrev_b32 v24, 16, v80
  v_and_b32 v25, s78, v80
  v_lshlrev_b32 v26, 16, v81
  v_and_b32 v27, s78, v81
  v_lshlrev_b32 v28, 16, v82
  v_and_b32 v29, s78, v82
  v_lshlrev_b32 v30, 16, v83
  v_and_b32 v31, s78, v83
  v_fma_f32 v24, v24, s77, -v6
  v_fma_f32 v25, v25, s77, -v6
  v_fma_f32 v26, v26, s77, -v6
  v_fma_f32 v27, v27, s77, -v6
  v_fma_f32 v28, v28, s77, -v6
  v_fma_f32 v29, v29, s77, -v6
  v_fma_f32 v30, v30, s77, -v6
  v_fma_f32 v31, v31, s77, -v6
  v_exp_f32 v24, v24
  v_exp_f32 v25, v25
  v_exp_f32 v26, v26
  v_exp_f32 v27, v27
  v_exp_f32 v28, v28
  v_exp_f32 v29, v29
  v_exp_f32 v30, v30
  v_exp_f32 v31, v31
  s_nop 0
  v_cvt_pk_bf16_f32 v80, v24, v25
  v_cvt_pk_bf16_f32 v81, v26, v27
  v_cvt_pk_bf16_f32 v82, v28, v29
  v_cvt_pk_bf16_f32 v83, v30, v31
  v_add_f32 v24, v24, v25
  v_add_f32 v26, v26, v27
  v_add_f32 v28, v28, v29
  v_add_f32 v30, v30, v31
  v_add_f32 v24, v24, v26
  v_add_f32 v28, v28, v30
  v_add_f32 v24, v24, v28
  v_add_f32 v5, v5, v24
  s_waitcnt vmcnt(5)
  s_add_u32 s89, s3, 3
  s_and_b32 s89, s89, 15
  s_lshl_b32 s89, s89, 20
  s_add_u32 s89, s89, s72
  buffer_load_dwordx4 v[176:179], v3, s[32:35], s89 offen offset:0 nt
  v_lshlrev_b32 v24, 16, v84
  v_and_b32 v25, s78, v84
  v_lshlrev_b32 v26, 16, v85
  v_and_b32 v27, s78, v85
  v_lshlrev_b32 v28, 16, v86
  v_and_b32 v29, s78, v86
  v_lshlrev_b32 v30, 16, v87
  v_and_b32 v31, s78, v87
  v_fma_f32 v24, v24, s77, -v6
  v_fma_f32 v25, v25, s77, -v6
  v_fma_f32 v26, v26, s77, -v6
  v_fma_f32 v27, v27, s77, -v6
  v_fma_f32 v28, v28, s77, -v6
  v_fma_f32 v29, v29, s77, -v6
  v_fma_f32 v30, v30, s77, -v6
  v_fma_f32 v31, v31, s77, -v6
  v_exp_f32 v24, v24
  v_exp_f32 v25, v25
  v_exp_f32 v26, v26
  v_exp_f32 v27, v27
  v_exp_f32 v28, v28
  v_exp_f32 v29, v29
  v_exp_f32 v30, v30
  v_exp_f32 v31, v31
  s_nop 0
  v_cvt_pk_bf16_f32 v84, v24, v25
  v_cvt_pk_bf16_f32 v85, v26, v27
  v_cvt_pk_bf16_f32 v86, v28, v29
  v_cvt_pk_bf16_f32 v87, v30, v31
  v_add_f32 v24, v24, v25
  v_add_f32 v26, v26, v27
  v_add_f32 v28, v28, v29
  v_add_f32 v30, v30, v31
  v_add_f32 v24, v24, v26
  v_add_f32 v28, v28, v30
  v_add_f32 v24, v24, v28
  v_add_f32 v5, v5, v24
  s_waitcnt vmcnt(5)
  buffer_load_dwordx4 v[180:183], v3, s[32:35], s89 offen offset:1024 nt
  v_lshlrev_b32 v24, 16, v88
  v_and_b32 v25, s78, v88
  v_lshlrev_b32 v26, 16, v89
  v_and_b32 v27, s78, v89
  v_lshlrev_b32 v28, 16, v90
  v_and_b32 v29, s78, v90
  v_lshlrev_b32 v30, 16, v91
  v_and_b32 v31, s78, v91
  v_fma_f32 v24, v24, s77, -v6
  v_fma_f32 v25, v25, s77, -v6
  v_fma_f32 v26, v26, s77, -v6
  v_fma_f32 v27, v27, s77, -v6
  v_fma_f32 v28, v28, s77, -v6
  v_fma_f32 v29, v29, s77, -v6
  v_fma_f32 v30, v30, s77, -v6
  v_fma_f32 v31, v31, s77, -v6
  v_exp_f32 v24, v24
  v_exp_f32 v25, v25
  v_exp_f32 v26, v26
  v_exp_f32 v27, v27
  v_exp_f32 v28, v28
  v_exp_f32 v29, v29
  v_exp_f32 v30, v30
  v_exp_f32 v31, v31
  s_nop 0
  v_cvt_pk_bf16_f32 v88, v24, v25
  v_cvt_pk_bf16_f32 v89, v26, v27
  v_cvt_pk_bf16_f32 v90, v28, v29
  v_cvt_pk_bf16_f32 v91, v30, v31
  v_add_f32 v24, v24, v25
  v_add_f32 v26, v26, v27
  v_add_f32 v28, v28, v29
  v_add_f32 v30, v30, v31
  v_add_f32 v24, v24, v26
  v_add_f32 v28, v28, v30
  v_add_f32 v24, v24, v28
  v_add_f32 v5, v5, v24
  s_waitcnt vmcnt(5)
  buffer_load_dwordx4 v[184:187], v3, s[32:35], s89 offen offset:2048 nt
  v_lshlrev_b32 v24, 16, v92
  v_and_b32 v25, s78, v92
  v_lshlrev_b32 v26, 16, v93
  v_and_b32 v27, s78, v93
  v_lshlrev_b32 v28, 16, v94
  v_and_b32 v29, s78, v94
  v_lshlrev_b32 v30, 16, v95
  v_and_b32 v31, s78, v95
  v_fma_f32 v24, v24, s77, -v6
  v_fma_f32 v25, v25, s77, -v6
  v_fma_f32 v26, v26, s77, -v6
  v_fma_f32 v27, v27, s77, -v6
  v_fma_f32 v28, v28, s77, -v6
  v_fma_f32 v29, v29, s77, -v6
  v_fma_f32 v30, v30, s77, -v6
  v_fma_f32 v31, v31, s77, -v6
  v_exp_f32 v24, v24
  v_exp_f32 v25, v25
  v_exp_f32 v26, v26
  v_exp_f32 v27, v27
  v_exp_f32 v28, v28
  v_exp_f32 v29, v29
  v_exp_f32 v30, v30
  v_exp_f32 v31, v31
  s_nop 0
  v_cvt_pk_bf16_f32 v92, v24, v25
  v_cvt_pk_bf16_f32 v93, v26, v27
  v_cvt_pk_bf16_f32 v94, v28, v29
  v_cvt_pk_bf16_f32 v95, v30, v31
  v_add_f32 v24, v24, v25
  v_add_f32 v26, v26, v27
  v_add_f32 v28, v28, v29
  v_add_f32 v30, v30, v31
  v_add_f32 v24, v24, v26
  v_add_f32 v28, v28, v30
  v_add_f32 v24, v24, v28
  v_add_f32 v5, v5, v24
  s_waitcnt vmcnt(5)
  buffer_load_dwordx4 v[188:191], v3, s[32:35], s89 offen offset:3072 nt
  v_mov_b32 v24, v5
  s_nop 1
  v_permlane16_swap_b32 v5, v24
  v_add_f32 v5, v5, v24
  v_mov_b32 v24, v5
  s_nop 1
  v_permlane32_swap_b32 v5, v24
  v_add_f32 v5, v5, v24
  v_mov_b32 v24, v7
  v_mov_b32 v25, v5
  s_lshl_b32 s73, s68, 5
  s_add_u32 s73, s73, 9216
  v_lshlrev_b32 v26, 3, v1
  v_add_u32 v26, s73, v26
  s_mov_b64 exec, 0xf
  ds_write_b64 v26, v[24:25]
  s_mov_b64 exec, -1
  s_waitcnt lgkmcnt(0)
  s_barrier
  s_cmp_lg_u32 s68, 4
  s_cbranch_scc1 Lw_11
  v_and_b32 v26, 31, v1
  v_lshlrev_b32 v26, 3, v26
  ds_read_b64 v[24:25], v26 offset:9216
  s_waitcnt lgkmcnt(0)
  v_mov_b32 v27, v24
  s_nop 1
  v_max_f32_dpp v27, v27, v27 row_ror:4 row_mask:0xf bank_mask:0xf
  s_nop 1
  v_max_f32_dpp v27, v27, v27 row_ror:8 row_mask:0xf bank_mask:0xf
  v_mov_b32 v28, v27
  s_nop 1
  v_permlane16_swap_b32 v27, v28
  v_max_f32 v27, v27, v28
  v_sub_f32 v24, v24, v27
  v_mul_f32 v24, s77, v24
  v_exp_f32 v24, v24
  s_nop 0
  v_mul_f32 v25, v25, v24
  s_nop 1
  v_add_f32_dpp v25, v25, v25 row_ror:4 row_mask:0xf bank_mask:0xf
  s_nop 1
  v_add_f32_dpp v25, v25, v25 row_ror:8 row_mask:0xf bank_mask:0xf
  v_mov_b32 v28, v25
  s_nop 1
  v_permlane16_swap_b32 v25, v28
  v_add_f32 v25, v25, v28
  v_mov_b32 v28, v27
  v_mov_b32 v29, s71
  v_mov_b32 v30, v25
  v_mov_b32 v31, s71
  s_lshl_b32 s73, s92, 6
  s_add_u32 s73, s73, 32768
  s_mov_b64 exec, 0xf
  buffer_store_dwordx4 v[28:31], v3, s[64:67], s73 offen sc1
  s_mov_b64 exec, -1
Lw_11:
  s_waitcnt vmcnt(5)
  s_add_u32 s89, s3, 4
  s_and_b32 s89, s89, 15
  s_lshl_b32 s89, s89, 20
  s_add_u32 s89, s89, s72
  buffer_load_dwordx4 v[192:195], v3, s[32:35], s89 offen offset:0 nt
  v_perm_b32 v16, v132, v128, s74
  v_perm_b32 v17, v140, v136, s74
  v_perm_b32 v18, v148, v144, s74
  v_perm_b32 v19, v156, v152, s74
  v_perm_b32 v20, v132, v128, s75
  v_perm_b32 v21, v140, v136, s75
  v_perm_b32 v22, v148, v144, s75
  v_perm_b32 v23, v156, v152, s75
  v_perm_b32 v24, v133, v129, s74
  v_perm_b32 v25, v141, v137, s74
  v_perm_b32 v26, v149, v145, s74
  v_perm_b32 v27, v157, v153, s74
  v_perm_b32 v28, v133, v129, s75
  v_perm_b32 v29, v141, v137, s75
  v_perm_b32 v30, v149, v145, s75
  v_perm_b32 v31, v157, v153, s75
  s_nop 1
  v_mfma_f32_16x16x32_bf16 v[96:99], v[64:67], v[16:19], 0
  v_mfma_f32_16x16x32_bf16 v[100:103], v[64:67], v[20:23], 0
  v_mfma_f32_16x16x32_bf16 v[104:107], v[64:67], v[24:27], 0
  v_mfma_f32_16x16x32_bf16 v[108:111], v[64:67], v[28:31], 0
  s_waitcnt vmcnt(5)
  buffer_load_dwordx4 v[196:199], v3, s[32:35], s89 offen offset:1024 nt
  v_perm_b32 v16, v134, v130, s74
  v_perm_b32 v17, v142, v138, s74
  v_perm_b32 v18, v150, v146, s74
  v_perm_b32 v19, v158, v154, s74
  v_perm_b32 v20, v134, v130, s75
  v_perm_b32 v21, v142, v138, s75
  v_perm_b32 v22, v150, v146, s75
  v_perm_b32 v23, v158, v154, s75
  v_perm_b32 v24, v135, v131, s74
  v_perm_b32 v25, v143, v139, s74
  v_perm_b32 v26, v151, v147, s74
  v_perm_b32 v27, v159, v155, s74
  v_perm_b32 v28, v135, v131, s75
  v_perm_b32 v29, v143, v139, s75
  v_perm_b32 v30, v151, v147, s75
  v_perm_b32 v31, v159, v155, s75
  s_nop 1
  v_mfma_f32_16x16x32_bf16 v[112:115], v[64:67], v[16:19], 0
  v_mfma_f32_16x16x32_bf16 v[116:119], v[64:67], v[20:23], 0
  v_mfma_f32_16x16x32_bf16 v[120:123], v[64:67], v[24:27], 0
  v_mfma_f32_16x16x32_bf16 v[124:127], v[64:67], v[28:31], 0
  s_waitcnt vmcnt(5)
  buffer_load_dwordx4 v[200:203], v3, s[32:35], s89 offen offset:2048 nt
  s_waitcnt vmcnt(5)
  buffer_load_dwordx4 v[204:207], v3, s[32:35], s89 offen offset:3072 nt
  s_waitcnt vmcnt(5)
  s_add_u32 s89, s3, 5
  s_and_b32 s89, s89, 15
  s_lshl_b32 s89, s89, 20
  s_add_u32 s89, s89, s72
  buffer_load_dwordx4 v[208:211], v3, s[32:35], s89 offen offset:0 nt
  s_waitcnt vmcnt(5)
  buffer_load_dwordx4 v[212:215], v3, s[32:35], s89 offen offset:1024 nt
  v_perm_b32 v16, v164, v160, s74
  v_perm_b32 v17, v172, v168, s74
  v_perm_b32 v18, v180, v176, s74
  v_perm_b32 v19, v188, v184, s74
  v_perm_b32 v20, v164, v160, s75
  v_perm_b32 v21, v172, v168, s75
  v_perm_b32 v22, v180, v176, s75
  v_perm_b32 v23, v188, v184, s75
  v_perm_b32 v24, v165, v161, s74
  v_perm_b32 v25, v173, v169, s74
  v_perm_b32 v26, v181, v177, s74
  v_perm_b32 v27, v189, v185, s74
  v_perm_b32 v28, v165, v161, s75
  v_perm_b32 v29, v173, v169, s75
  v_perm_b32 v30, v181, v177, s75
  v_perm_b32 v31, v189, v185, s75
  s_nop 1
  v_mfma_f32_16x16x32_bf16 v[96:99], v[68:71], v[16:19], v[96:99]
  v_mfma_f32_16x16x32_bf16 v[100:103], v[68:71], v[20:23], v[100:103]
  v_mfma_f32_16x16x32_bf16 v[104:107], v[68:71], v[24:27], v[104:107]
  v_mfma_f32_16x16x32_bf16 v[108:111], v[68:71], v[28:31], v[108:111]
  s_waitcnt vmcnt(5)
  buffer_load_dwordx4 v[216:219], v3, s[32:35], s89 offen offset:2048 nt
  v_perm_b32 v16, v166, v162, s74
  v_perm_b32 v17, v174, v170, s74
  v_perm_b32 v18, v182, v178, s74
  v_perm_b32 v19, v190, v186, s74
  v_perm_b32 v20, v166, v162, s75
  v_perm_b32 v21, v174, v170, s75
  v_perm_b32 v22, v182, v178, s75
  v_perm_b32 v23, v190, v186, s75
  v_perm_b32 v24, v167, v163, s74
  v_perm_b32 v25, v175, v171, s74
  v_perm_b32 v26, v183, v179, s74
  v_perm_b32 v27, v191, v187, s74
  v_perm_b32 v28, v167, v163, s75
  v_perm_b32 v29, v175, v171, s75
  v_perm_b32 v30, v183, v179, s75
  v_perm_b32 v31, v191, v187, s75
  s_nop 1
  v_mfma_f32_16x16x32_bf16 v[112:115], v[68:71], v[16:19], v[112:115]
  v_mfma_f32_16x16x32_bf16 v[116:119], v[68:71], v[20:23], v[116:119]
  v_mfma_f32_16x16x32_bf16 v[120:123], v[68:71], v[24:27], v[120:123]
  v_mfma_f32_16x16x32_bf16 v[124:127], v[68:71], v[28:31], v[124:127]
  s_waitcnt vmcnt(5)
  buffer_load_dwordx4 v[220:223], v3, s[32:35], s89 offen offset:3072 nt
  s_waitcnt vmcnt(5)
  s_add_u32 s89, s3, 6
  s_and_b32 s89, s89, 15
  s_lshl_b32 s89, s89, 20
  s_add_u32 s89, s89, s72
  buffer_load_dwordx4 v[224:227], v3, s[32:35], s89 offen offset:0 nt
  s_waitcnt vmcnt(5)
  buffer_load_dwordx4 v[228:231], v3, s[32:35], s89 offen offset:1024 nt
  s_waitcnt vmcnt(5)
  buffer_load_dwordx4 v[232:235], v3, s[32:35], s89 offen offset:2048 nt
  s_waitcnt vmcnt(5)
  buffer_load_dwordx4 v[236:239], v3, s[32:35], s89 offen offset:3072 nt
  s_waitcnt vmcnt(5)
  s_add_u32 s89, s3, 7
  s_and_b32 s89, s89, 15
  s_lshl_b32 s89, s89, 20
  s_add_u32 s89, s89, s72
  buffer_load_dwordx4 v[240:243], v3, s[32:35], s89 offen offset:0 nt
  s_waitcnt vmcnt(5)
  buffer_load_dwordx4 v[244:247], v3, s[32:35], s89 offen offset:1024 nt
  v_perm_b32 v16, v196, v192, s74
  v_perm_b32 v17, v204, v200, s74
  v_perm_b32 v18, v212, v208, s74
  v_perm_b32 v19, v220, v216, s74
  v_perm_b32 v20, v196, v192, s75
  v_perm_b32 v21, v204, v200, s75
  v_perm_b32 v22, v212, v208, s75
  v_perm_b32 v23, v220, v216, s75
  v_perm_b32 v24, v197, v193, s74
  v_perm_b32 v25, v205, v201, s74
  v_perm_b32 v26, v213, v209, s74
  v_perm_b32 v27, v221, v217, s74
  v_perm_b32 v28, v197, v193, s75
  v_perm_b32 v29, v205, v201, s75
  v_perm_b32 v30, v213, v209, s75
  v_perm_b32 v31, v221, v217, s75
  s_nop 1
  v_mfma_f32_16x16x32_bf16 v[96:99], v[72:75], v[16:19], v[96:99]
  v_mfma_f32_16x16x32_bf16 v[100:103], v[72:75], v[20:23], v[100:103]
  v_mfma_f32_16x16x32_bf16 v[104:107], v[72:75], v[24:27], v[104:107]
  v_mfma_f32_16x16x32_bf16 v[108:111], v[72:75], v[28:31], v[108:111]
  s_waitcnt vmcnt(5)
  buffer_load_dwordx4 v[248:251], v3, s[32:35], s89 offen offset:2048 nt
  v_perm_b32 v16, v198, v194, s74
  v_perm_b32 v17, v206, v202, s74
  v_perm_b32 v18, v214, v210, s74
  v_perm_b32 v19, v222, v218, s74
  v_perm_b32 v20, v198, v194, s75
  v_perm_b32 v21, v206, v202, s75
  v_perm_b32 v22, v214, v210, s75
  v_perm_b32 v23, v222, v218, s75
  v_perm_b32 v24, v199, v195, s74
  v_perm_b32 v25, v207, v203, s74
  v_perm_b32 v26, v215, v211, s74
  v_perm_b32 v27, v223, v219, s74
  v_perm_b32 v28, v199, v195, s75
  v_perm_b32 v29, v207, v203, s75
  v_perm_b32 v30, v215, v211, s75
  v_perm_b32 v31, v223, v219, s75
  s_nop 1
  v_mfma_f32_16x16x32_bf16 v[112:115], v[72:75], v[16:19], v[112:115]
  v_mfma_f32_16x16x32_bf16 v[116:119], v[72:75], v[20:23], v[116:119]
  v_mfma_f32_16x16x32_bf16 v[120:123], v[72:75], v[24:27], v[120:123]
  v_mfma_f32_16x16x32_bf16 v[124:127], v[72:75], v[28:31], v[124:127]
  s_waitcnt vmcnt(5)
  buffer_load_dwordx4 v[252:255], v3, s[32:35], s89 offen offset:3072 nt
  s_waitcnt vmcnt(5)
  s_add_u32 s89, s3, 8
  s_and_b32 s89, s89, 15
  s_lshl_b32 s89, s89, 20
  s_add_u32 s89, s89, s72
  buffer_load_dwordx4 v[128:131], v3, s[32:35], s89 offen offset:0 nt
  s_waitcnt vmcnt(5)
  buffer_load_dwordx4 v[132:135], v3, s[32:35], s89 offen offset:1024 nt
  s_waitcnt vmcnt(5)
  buffer_load_dwordx4 v[136:139], v3, s[32:35], s89 offen offset:2048 nt
  s_waitcnt vmcnt(5)
  buffer_load_dwordx4 v[140:143], v3, s[32:35], s89 offen offset:3072 nt
  s_cmp_lg_u32 s68, 5
  s_cbranch_scc1 Lw_12
  s_lshl_b32 s73, s69, 11
  s_add_u32 s73, s73, 32768
  buffer_load_dwordx4 v[56:59], v3, s[64:67], s73 offen offset:0 sc1
  buffer_load_dwordx4 v[60:63], v3, s[64:67], s73 offen offset:1024 sc1
Lw_12:
  s_waitcnt vmcnt(5)
  s_add_u32 s89, s3, 9
  s_and_b32 s89, s89, 15
  s_lshl_b32 s89, s89, 20
  s_add_u32 s89, s89, s72
  buffer_load_dwordx4 v[144:147], v3, s[32:35], s89 offen offset:0 nt
  s_waitcnt vmcnt(5)
  buffer_load_dwordx4 v[148:151], v3, s[32:35], s89 offen offset:1024 nt
  v_perm_b32 v16, v228, v224, s74
  v_perm_b32 v17, v236, v232, s74
  v_perm_b32 v18, v244, v240, s74
  v_perm_b32 v19, v252, v248, s74
  v_perm_b32 v20, v228, v224, s75
  v_perm_b32 v21, v236, v232, s75
  v_perm_b32 v22, v244, v240, s75
  v_perm_b32 v23, v252, v248, s75
  v_perm_b32 v24, v229, v225, s74
  v_perm_b32 v25, v237, v233, s74
  v_perm_b32 v26, v245, v241, s74
  v_perm_b32 v27, v253, v249, s74
  v_perm_b32 v28, v229, v225, s75
  v_perm_b32 v29, v237, v233, s75
  v_perm_b32 v30, v245, v241, s75
  v_perm_b32 v31, v253, v249, s75
  s_nop 1
  v_mfma_f32_16x16x32_bf16 v[96:99], v[76:79], v[16:19], v[96:99]
  v_mfma_f32_16x16x32_bf16 v[100:103], v[76:79], v[20:23], v[100:103]
  v_mfma_f32_16x16x32_bf16 v[104:107], v[76:79], v[24:27], v[104:107]
  v_mfma_f32_16x16x32_bf16 v[108:111], v[76:79], v[28:31], v[108:111]
  s_waitcnt vmcnt(5)
  buffer_load_dwordx4 v[152:155], v3, s[32:35], s89 offen offset:2048 nt
  v_perm_b32 v16, v230, v226, s74
  v_perm_b32 v17, v238, v234, s74
  v_perm_b32 v18, v246, v242, s74
  v_perm_b32 v19, v254, v250, s74
  v_perm_b32 v20, v230, v226, s75
  v_perm_b32 v21, v238, v234, s75
  v_perm_b32 v22, v246, v242, s75
  v_perm_b32 v23, v254, v250, s75
  v_perm_b32 v24, v231, v227, s74
  v_perm_b32 v25, v239, v235, s74
  v_perm_b32 v26, v247, v243, s74
  v_perm_b32 v27, v255, v251, s74
  v_perm_b32 v28, v231, v227, s75
  v_perm_b32 v29, v239, v235, s75
  v_perm_b32 v30, v247, v243, s75
  v_perm_b32 v31, v255, v251, s75
  s_nop 1
  v_mfma_f32_16x16x32_bf16 v[112:115], v[76:79], v[16:19], v[112:115]
  v_mfma_f32_16x16x32_bf16 v[116:119], v[76:79], v[20:23], v[116:119]
  v_mfma_f32_16x16x32_bf16 v[120:123], v[76:79], v[24:27], v[120:123]
  v_mfma_f32_16x16x32_bf16 v[124:127], v[76:79], v[28:31], v[124:127]
  s_waitcnt vmcnt(5)
  buffer_load_dwordx4 v[156:159], v3, s[32:35], s89 offen offset:3072 nt
  s_barrier
  s_waitcnt vmcnt(5)
  s_add_u32 s89, s3, 10
  s_and_b32 s89, s89, 15
  s_lshl_b32 s89, s89, 20
  s_add_u32 s89, s89, s72
  buffer_load_dwordx4 v[160:163], v3, s[32:35], s89 offen offset:0 nt
  s_waitcnt vmcnt(5)
  buffer_load_dwordx4 v[164:167], v3, s[32:35], s89 offen offset:1024 nt
  s_waitcnt vmcnt(5)
  buffer_load_dwordx4 v[168:171], v3, s[32:35], s89 offen offset:2048 nt
  s_waitcnt vmcnt(5)
  buffer_load_dwordx4 v[172:175], v3, s[32:35], s89 offen offset:3072 nt
  s_waitcnt vmcnt(5)
  s_add_u32 s89, s3, 11
  s_and_b32 s89, s89, 15
  s_lshl_b32 s89, s89, 20
  s_add_u32 s89, s89, s72
  buffer_load_dwordx4 v[176:179], v3, s[32:35], s89 offen offset:0 nt
  s_waitcnt vmcnt(5)
  buffer_load_dwordx4 v[180:183], v3, s[32:35], s89 offen offset:1024 nt
  v_perm_b32 v16, v132, v128, s74
  v_perm_b32 v17, v140, v136, s74
  v_perm_b32 v18, v148, v144, s74
  v_perm_b32 v19, v156, v152, s74
  v_perm_b32 v20, v132, v128, s75
  v_perm_b32 v21, v140, v136, s75
  v_perm_b32 v22, v148, v144, s75
  v_perm_b32 v23, v156, v152, s75
  v_perm_b32 v24, v133, v129, s74
  v_perm_b32 v25, v141, v137, s74
  v_perm_b32 v26, v149, v145, s74
  v_perm_b32 v27, v157, v153, s74
  v_perm_b32 v28, v133, v129, s75
  v_perm_b32 v29, v141, v137, s75
  v_perm_b32 v30, v149, v145, s75
  v_perm_b32 v31, v157, v153, s75
  s_nop 1
  v_mfma_f32_16x16x32_bf16 v[96:99], v[80:83], v[16:19], v[96:99]
  v_mfma_f32_16x16x32_bf16 v[100:103], v[80:83], v[20:23], v[100:103]
  v_mfma_f32_16x16x32_bf16 v[104:107], v[80:83], v[24:27], v[104:107]
  v_mfma_f32_16x16x32_bf16 v[108:111], v[80:83], v[28:31], v[108:111]
  s_waitcnt vmcnt(5)
  buffer_load_dwordx4 v[184:187], v3, s[32:35], s89 offen offset:2048 nt
  v_perm_b32 v16, v134, v130, s74
  v_perm_b32 v17, v142, v138, s74
  v_perm_b32 v18, v150, v146, s74
  v_perm_b32 v19, v158, v154, s74
  v_perm_b32 v20, v134, v130, s75
  v_perm_b32 v21, v142, v138, s75
  v_perm_b32 v22, v150, v146, s75
  v_perm_b32 v23, v158, v154, s75
  v_perm_b32 v24, v135, v131, s74
  v_perm_b32 v25, v143, v139, s74
  v_perm_b32 v26, v151, v147, s74
  v_perm_b32 v27, v159, v155, s74
  v_perm_b32 v28, v135, v131, s75
  v_perm_b32 v29, v143, v139, s75
  v_perm_b32 v30, v151, v147, s75
  v_perm_b32 v31, v159, v155, s75
  s_nop 1
  v_mfma_f32_16x16x32_bf16 v[112:115], v[80:83], v[16:19], v[112:115]
  v_mfma_f32_16x16x32_bf16 v[116:119], v[80:83], v[20:23], v[116:119]
  v_mfma_f32_16x16x32_bf16 v[120:123], v[80:83], v[24:27], v[120:123]
  v_mfma_f32_16x16x32_bf16 v[124:127], v[80:83], v[28:31], v[124:127]
  s_waitcnt vmcnt(5)
  buffer_load_dwordx4 v[188:191], v3, s[32:35], s89 offen offset:3072 nt
  s_cmp_lg_u32 s68, 5
  s_cbranch_scc1 Lw_13
  s_mov_b32 s94, 0
Lmc_16:
  v_xor_b32 v24, s71, v57
  v_xor_b32 v25, s71, v59
  v_or_b32 v24, v24, v25
  v_xor_b32 v25, s71, v61
  v_or_b32 v24, v24, v25
  v_xor_b32 v25, s71, v63
  v_or_b32 v24, v24, v25
  v_cmp_ne_u32 vcc, 0, v24
  s_cmp_lg_u64 vcc, 0
  s_cbranch_scc1 Lmr_14
  s_branch Lmok_15
Lmr_14:
  s_add_u32 s94, s94, 1
  s_cmp_gt_u32 s94, 262144
  s_cbranch_scc1 L_end
  s_lshl_b32 s73, s69, 11
  s_add_u32 s73, s73, 32768
  buffer_load_dwordx4 v[56:59], v3, s[64:67], s73 offen offset:0 sc1
  buffer_load_dwordx4 v[60:63], v3, s[64:67], s73 offen offset:1024 sc1
  s_waitcnt vmcnt(0)
  s_branch Lmc_16
Lmok_15:
  v_max_f32 v24, v56, v60
  s_nop 1
  v_max_f32_dpp v24, v24, v24 row_ror:4 row_mask:0xf bank_mask:0xf
  s_nop 1
  v_max_f32_dpp v24, v24, v24 row_ror:8 row_mask:0xf bank_mask:0xf
  v_mov_b32 v25, v24
  s_nop 1
  v_permlane16_swap_b32 v24, v25
  v_max_f32 v24, v24, v25
  v_mov_b32 v25, v24
  s_nop 1
  v_permlane32_swap_b32 v24, v25
  v_max_f32 v24, v24, v25
  v_sub_f32 v56, v56, v24
  v_sub_f32 v60, v60, v24
  v_mul_f32 v56, s77, v56
  v_mul_f32 v60, s77, v60
  v_exp_f32 v56, v56
  v_exp_f32 v60, v60
  s_nop 0
  v_mul_f32 v58, v58, v56
  v_fmac_f32 v58, v62, v60
  s_nop 1
  v_add_f32_dpp v58, v58, v58 row_ror:4 row_mask:0xf bank_mask:0xf
  s_nop 1
  v_add_f32_dpp v58, v58, v58 row_ror:8 row_mask:0xf bank_mask:0xf
  v_mov_b32 v25, v58
  s_nop 1
  v_permlane16_swap_b32 v58, v25
  v_add_f32 v58, v58, v25
  v_mov_b32 v25, v58
  s_nop 1
  v_permlane32_swap_b32 v58, v25
  v_add_f32 v58, v58, v25
  v_and_b32 v26, 31, v1
  v_lshlrev_b32 v27, 3, v26
  ds_read_b32 v28, v27 offset:9216
  v_rcp_f32 v29, v58
  s_waitcnt lgkmcnt(0)
  v_sub_f32 v28, v28, v24
  v_mul_f32 v28, s77, v28
  v_exp_f32 v28, v28
  v_fma_f32 v30, -v29, v58, 1.0
  v_fma_f32 v29, v30, v29, v29
  v_mul_f32 v28, v28, v29
  v_lshlrev_b32 v27, 2, v26
  ds_write_b32 v27, v28 offset:9600
Lw_13:
  s_waitcnt vmcnt(5)
  s_add_u32 s89, s3, 12
  s_and_b32 s89, s89, 15
  s_lshl_b32 s89, s89, 20
  s_add_u32 s89, s89, s72
  buffer_load_dwordx4 v[192:195], v3, s[32:35], s89 offen offset:0 nt
  s_waitcnt vmcnt(5)
  buffer_load_dwordx4 v[196:199], v3, s[32:35], s89 offen offset:1024 nt
  s_waitcnt vmcnt(5)
  buffer_load_dwordx4 v[200:203], v3, s[32:35], s89 offen offset:2048 nt
  s_waitcnt vmcnt(5)
  buffer_load_dwordx4 v[204:207], v3, s[32:35], s89 offen offset:3072 nt
  s_waitcnt vmcnt(5)
  s_add_u32 s89, s3, 13
  s_and_b32 s89, s89, 15
  s_lshl_b32 s89, s89, 20
  s_add_u32 s89, s89, s72
  buffer_load_dwordx4 v[208:211], v3, s[32:35], s89 offen offset:0 nt
  s_waitcnt vmcnt(5)
  buffer_load_dwordx4 v[212:215], v3, s[32:35], s89 offen offset:1024 nt
  v_perm_b32 v16, v164, v160, s74
  v_perm_b32 v17, v172, v168, s74
  v_perm_b32 v18, v180, v176, s74
  v_perm_b32 v19, v188, v184, s74
  v_perm_b32 v20, v164, v160, s75
  v_perm_b32 v21, v172, v168, s75
  v_perm_b32 v22, v180, v176, s75
  v_perm_b32 v23, v188, v184, s75
  v_perm_b32 v24, v165, v161, s74
  v_perm_b32 v25, v173, v169, s74
  v_perm_b32 v26, v181, v177, s74
  v_perm_b32 v27, v189, v185, s74
  v_perm_b32 v28, v165, v161, s75
  v_perm_b32 v29, v173, v169, s75
  v_perm_b32 v30, v181, v177, s75
  v_perm_b32 v31, v189, v185, s75
  s_nop 1
  v_mfma_f32_16x16x32_bf16 v[96:99], v[84:87], v[16:19], v[96:99]
  v_mfma_f32_16x16x32_bf16 v[100:103], v[84:87], v[20:23], v[100:103]
  v_mfma_f32_16x16x32_bf16 v[104:107], v[84:87], v[24:27], v[104:107]
  v_mfma_f32_16x16x32_bf16 v[108:111], v[84:87], v[28:31], v[108:111]
  s_waitcnt vmcnt(5)
  buffer_load_dwordx4 v[216:219], v3, s[32:35], s89 offen offset:2048 nt
  v_perm_b32 v16, v166, v162, s74
  v_perm_b32 v17, v174, v170, s74
  v_perm_b32 v18, v182, v178, s74
  v_perm_b32 v19, v190, v186, s74
  v_perm_b32 v20, v166, v162, s75
  v_perm_b32 v21, v174, v170, s75
  v_perm_b32 v22, v182, v178, s75
  v_perm_b32 v23, v190, v186, s75
  v_perm_b32 v24, v167, v163, s74
  v_perm_b32 v25, v175, v171, s74
  v_perm_b32 v26, v183, v179, s74
  v_perm_b32 v27, v191, v187, s74
  v_perm_b32 v28, v167, v163, s75
  v_perm_b32 v29, v175, v171, s75
  v_perm_b32 v30, v183, v179, s75
  v_perm_b32 v31, v191, v187, s75
  s_nop 1
  v_mfma_f32_16x16x32_bf16 v[112:115], v[84:87], v[16:19], v[112:115]
  v_mfma_f32_16x16x32_bf16 v[116:119], v[84:87], v[20:23], v[116:119]
  v_mfma_f32_16x16x32_bf16 v[120:123], v[84:87], v[24:27], v[120:123]
  v_mfma_f32_16x16x32_bf16 v[124:127], v[84:87], v[28:31], v[124:127]
  s_waitcnt vmcnt(5)
  buffer_load_dwordx4 v[220:223], v3, s[32:35], s89 offen offset:3072 nt
  s_waitcnt lgkmcnt(0)
  s_barrier
  s_waitcnt vmcnt(5)
  s_add_u32 s89, s3, 14
  s_and_b32 s89, s89, 15
  s_lshl_b32 s89, s89, 20
  s_add_u32 s89, s89, s72
  buffer_load_dwordx4 v[224:227], v3, s[32:35], s89 offen offset:0 nt
  s_waitcnt vmcnt(5)
  buffer_load_dwordx4 v[228:231], v3, s[32:35], s89 offen offset:1024 nt
  s_waitcnt vmcnt(5)
  buffer_load_dwordx4 v[232:235], v3, s[32:35], s89 offen offset:2048 nt
  s_waitcnt vmcnt(5)
  buffer_load_dwordx4 v[236:239], v3, s[32:35], s89 offen offset:3072 nt
  s_waitcnt vmcnt(5)
  s_add_u32 s89, s3, 15
  s_and_b32 s89, s89, 15
  s_lshl_b32 s89, s89, 20
  s_add_u32 s89, s89, s72
  buffer_load_dwordx4 v[240:243], v3, s[32:35], s89 offen offset:0 nt
  s_waitcnt vmcnt(5)
  buffer_load_dwordx4 v[244:247], v3, s[32:35], s89 offen offset:1024 nt
  v_perm_b32 v16, v196, v192, s74
  v_perm_b32 v17, v204, v200, s74
  v_perm_b32 v18, v212, v208, s74
  v_perm_b32 v19, v220, v216, s74
  v_perm_b32 v20, v196, v192, s75
  v_perm_b32 v21, v204, v200, s75
  v_perm_b32 v22, v212, v208, s75
  v_perm_b32 v23, v220, v216, s75
  v_perm_b32 v24, v197, v193, s74
  v_perm_b32 v25, v205, v201, s74
  v_perm_b32 v26, v213, v209, s74
  v_perm_b32 v27, v221, v217, s74
  v_perm_b32 v28, v197, v193, s75
  v_perm_b32 v29, v205, v201, s75
  v_perm_b32 v30, v213, v209, s75
  v_perm_b32 v31, v221, v217, s75
  s_nop 1
  v_mfma_f32_16x16x32_bf16 v[96:99], v[88:91], v[16:19], v[96:99]
  v_mfma_f32_16x16x32_bf16 v[100:103], v[88:91], v[20:23], v[100:103]
  v_mfma_f32_16x16x32_bf16 v[104:107], v[88:91], v[24:27], v[104:107]
  v_mfma_f32_16x16x32_bf16 v[108:111], v[88:91], v[28:31], v[108:111]
  s_waitcnt vmcnt(5)
  buffer_load_dwordx4 v[248:251], v3, s[32:35], s89 offen offset:2048 nt
  v_perm_b32 v16, v198, v194, s74
  v_perm_b32 v17, v206, v202, s74
  v_perm_b32 v18, v214, v210, s74
  v_perm_b32 v19, v222, v218, s74
  v_perm_b32 v20, v198, v194, s75
  v_perm_b32 v21, v206, v202, s75
  v_perm_b32 v22, v214, v210, s75
  v_perm_b32 v23, v222, v218, s75
  v_perm_b32 v24, v199, v195, s74
  v_perm_b32 v25, v207, v203, s74
  v_perm_b32 v26, v215, v211, s74
  v_perm_b32 v27, v223, v219, s74
  v_perm_b32 v28, v199, v195, s75
  v_perm_b32 v29, v207, v203, s75
  v_perm_b32 v30, v215, v211, s75
  v_perm_b32 v31, v223, v219, s75
  s_nop 1
  v_mfma_f32_16x16x32_bf16 v[112:115], v[88:91], v[16:19], v[112:115]
  v_mfma_f32_16x16x32_bf16 v[116:119], v[88:91], v[20:23], v[116:119]
  v_mfma_f32_16x16x32_bf16 v[120:123], v[88:91], v[24:27], v[120:123]
  v_mfma_f32_16x16x32_bf16 v[124:127], v[88:91], v[28:31], v[124:127]
  s_waitcnt vmcnt(5)
  buffer_load_dwordx4 v[252:255], v3, s[32:35], s89 offen offset:3072 nt
  s_cmp_ge_u32 s91, 128
  s_cbranch_scc1 Lhv_17
  v_lshrrev_b32 v15, 3, v1
  v_mul_u32_u24 v15, 3584, v15
  v_and_b32 v9, 7, v1
  v_lshl_add_u32 v15, v9, 4, v15
  s_and_b32 s73, s79, 3
  s_lshl_b32 s73, s73, 3
  s_add_u32 s73, s73, s68
  s_mul_i32 s73, s73, 57344
  s_lshr_b32 s88, s79, 2
  s_lshl_b32 s88, s88, 7
  s_add_u32 s73, s73, s88
  buffer_load_dwordx4 v[128:131], v15, s[44:47], s73 offen nt
Lhv_17:
  s_cmp_ge_u32 s91, 128
  s_cbranch_scc1 Lhv_18
  v_lshrrev_b32 v15, 3, v1
  v_mul_u32_u24 v15, 3584, v15
  v_and_b32 v9, 7, v1
  v_lshl_add_u32 v15, v9, 4, v15
  s_and_b32 s73, s79, 3
  s_lshl_b32 s73, s73, 3
  s_add_u32 s73, s73, s68
  s_mul_i32 s73, s73, 57344
  s_lshr_b32 s88, s79, 2
  s_lshl_b32 s88, s88, 7
  s_add_u32 s73, s73, s88
  buffer_load_dwordx4 v[136:139], v15, s[48:51], s73 offen nt
Lhv_18:
  s_cmp_ge_u32 s91, 128
  s_cbranch_scc1 Lhv_19
  v_lshrrev_b32 v15, 3, v1
  v_mul_u32_u24 v15, 3584, v15
  v_and_b32 v9, 7, v1
  v_lshl_add_u32 v15, v9, 4, v15
  s_and_b32 s73, s79, 3
  s_lshl_b32 s73, s73, 3
  s_add_u32 s73, s73, s68
  s_mul_i32 s73, s73, 57344
  s_lshr_b32 s88, s79, 2
  s_lshl_b32 s88, s88, 7
  s_add_u32 s73, s73, s88
  s_add_u32 s73, s73, 28672
  buffer_load_dwordx4 v[132:135], v15, s[44:47], s73 offen nt
Lhv_19:
  s_cmp_ge_u32 s91, 128
  s_cbranch_scc1 Lhv_20
  v_lshrrev_b32 v15, 3, v1
  v_mul_u32_u24 v15, 3584, v15
  v_and_b32 v9, 7, v1
  v_lshl_add_u32 v15, v9, 4, v15
  s_and_b32 s73, s79, 3
  s_lshl_b32 s73, s73, 3
  s_add_u32 s73, s73, s68
  s_mul_i32 s73, s73, 57344
  s_lshr_b32 s88, s79, 2
  s_lshl_b32 s88, s88, 7
  s_add_u32 s73, s73, s88
  s_add_u32 s73, s73, 28672
  buffer_load_dwordx4 v[140:143], v15, s[48:51], s73 offen nt
Lhv_20:
  s_cmp_ge_u32 s91, 128
  s_cbranch_scc1 Lhv_21
  s_lshl_b32 s73, s79, 14
  s_mul_i32 s88, s68, 2
  s_add_u32 s88, s88, 0
  s_lshl_b32 s88, s88, 10
  s_add_u32 s73, s73, s88
  s_add_u32 m0, s88, 65536
  s_nop 0
  buffer_load_dwordx4 v3, s[52:55], s73 offen nt lds
Lhv_21:
  s_cmp_ge_u32 s91, 128
  s_cbranch_scc1 Lhv_22
  s_lshl_b32 s73, s79, 14
  s_mul_i32 s88, s68, 2
  s_add_u32 s88, s88, 1
  s_lshl_b32 s88, s88, 10
  s_add_u32 s73, s73, s88
  s_add_u32 m0, s88, 65536
  s_nop 0
  buffer_load_dwordx4 v3, s[52:55], s73 offen nt lds
Lhv_22:
  s_cmp_ge_u32 s91, 128
  s_cbranch_scc1 Lhv_23
  s_lshl_b32 s73, s91, 15
  s_mul_i32 s88, s68, 4
  s_add_u32 s88, s88, 0
  s_lshl_b32 s88, s88, 10
  s_add_u32 s73, s73, s88
  s_add_u32 m0, s88, 32768
  s_nop 0
  buffer_load_dwordx4 v3, s[40:43], s73 offen nt lds
Lhv_23:
  s_cmp_ge_u32 s91, 128
  s_cbranch_scc1 Lhv_24
  s_lshl_b32 s73, s91, 15
  s_mul_i32 s88, s68, 4
  s_add_u32 s88, s88, 1
  s_lshl_b32 s88, s88, 10
  s_add_u32 s73, s73, s88
  s_add_u32 m0, s88, 32768
  s_nop 0
  buffer_load_dwordx4 v3, s[40:43], s73 offen nt lds
Lhv_24:
  s_cmp_ge_u32 s91, 128
  s_cbranch_scc1 Lhv_25
  s_lshl_b32 s73, s91, 15
  s_mul_i32 s88, s68, 4
  s_add_u32 s88, s88, 2
  s_lshl_b32 s88, s88, 10
  s_add_u32 s73, s73, s88
  s_add_u32 m0, s88, 32768
  s_nop 0
  buffer_load_dwordx4 v3, s[40:43], s73 offen nt lds
Lhv_25:
  s_cmp_ge_u32 s91, 128
  s_cbranch_scc1 Lhv_26
  s_lshl_b32 s73, s91, 15
  s_mul_i32 s88, s68, 4
  s_add_u32 s88, s88, 3
  s_lshl_b32 s88, s88, 10
  s_add_u32 s73, s73, s88
  s_add_u32 m0, s88, 32768
  s_nop 0
  buffer_load_dwordx4 v3, s[40:43], s73 offen nt lds
Lhv_26:
  s_cmp_ge_u32 s91, 128
  s_cbranch_scc1 Lx3_27
  s_waitcnt vmcnt(10)
  s_branch Lx3_28
Lx3_27:
  s_waitcnt vmcnt(0)
Lx3_28:
  v_perm_b32 v16, v228, v224, s74
  v_perm_b32 v17, v236, v232, s74
  v_perm_b32 v18, v244, v240, s74
  v_perm_b32 v19, v252, v248, s74
  v_perm_b32 v20, v228, v224, s75
  v_perm_b32 v21, v236, v232, s75
  v_perm_b32 v22, v244, v240, s75
  v_perm_b32 v23, v252, v248, s75
  v_perm_b32 v24, v229, v225, s74
  v_perm_b32 v25, v237, v233, s74
  v_perm_b32 v26, v245, v241, s74
  v_perm_b32 v27, v253, v249, s74
  v_perm_b32 v28, v229, v225, s75
  v_perm_b32 v29, v237, v233, s75
  v_perm_b32 v30, v245, v241, s75
  v_perm_b32 v31, v253, v249, s75
  s_nop 1
  v_mfma_f32_16x16x32_bf16 v[96:99], v[92:95], v[16:19], v[96:99]
  v_mfma_f32_16x16x32_bf16 v[100:103], v[92:95], v[20:23], v[100:103]
  v_mfma_f32_16x16x32_bf16 v[104:107], v[92:95], v[24:27], v[104:107]
  v_mfma_f32_16x16x32_bf16 v[108:111], v[92:95], v[28:31], v[108:111]
  s_cmp_ge_u32 s91, 128
  s_cbranch_scc1 Lx3_29
  s_waitcnt vmcnt(10)
  s_branch Lx3_30
Lx3_29:
  s_waitcnt vmcnt(0)
Lx3_30:
  v_perm_b32 v16, v230, v226, s74
  v_perm_b32 v17, v238, v234, s74
  v_perm_b32 v18, v246, v242, s74
  v_perm_b32 v19, v254, v250, s74
  v_perm_b32 v20, v230, v226, s75
  v_perm_b32 v21, v238, v234, s75
  v_perm_b32 v22, v246, v242, s75
  v_perm_b32 v23, v254, v250, s75
  v_perm_b32 v24, v231, v227, s74
  v_perm_b32 v25, v239, v235, s74
  v_perm_b32 v26, v247, v243, s74
  v_perm_b32 v27, v255, v251, s74
  v_perm_b32 v28, v231, v227, s75
  v_perm_b32 v29, v239, v235, s75
  v_perm_b32 v30, v247, v243, s75
  v_perm_b32 v31, v255, v251, s75
  s_nop 1
  v_mfma_f32_16x16x32_bf16 v[112:115], v[92:95], v[16:19], v[112:115]
  v_mfma_f32_16x16x32_bf16 v[116:119], v[92:95], v[20:23], v[116:119]
  v_mfma_f32_16x16x32_bf16 v[120:123], v[92:95], v[24:27], v[120:123]
  v_mfma_f32_16x16x32_bf16 v[124:127], v[92:95], v[28:31], v[124:127]
  s_cmp_ge_u32 s91, 128
  s_cbranch_scc1 Lhv_31
  s_waitcnt vmcnt(6)
  s_and_b32 s73, s79, 3
  s_lshl_b32 s73, s73, 3
  s_add_u32 s73, s73, s68
  s_lshl_b32 s73, s73, 5
  v_lshrrev_b32 v18, 3, v1
  v_lshlrev_b32 v18, 1, v18
  v_add_u32 v18, s73, v18
  ds_read_u16 v20, v18 offset:0
  ds_read_u16 v22, v18 offset:16
  s_waitcnt lgkmcnt(0)
  v_lshlrev_b32 v21, 16, v20
  v_lshlrev_b32 v23, 16, v22
  v_dot2_f32_bf16 v24, v128, v20, 0
  v_dot2_f32_bf16 v25, v128, v21, 0
  v_dot2_f32_bf16 v26, v129, v20, 0
  v_dot2_f32_bf16 v27, v129, v21, 0
  v_dot2_f32_bf16 v28, v130, v20, 0
  v_dot2_f32_bf16 v29, v130, v21, 0
  v_dot2_f32_bf16 v30, v131, v20, 0
  v_dot2_f32_bf16 v31, v131, v21, 0
  v_dot2_f32_bf16 v32, v136, v20, 0
  v_dot2_f32_bf16 v33, v136, v21, 0
  v_dot2_f32_bf16 v34, v137, v20, 0
  v_dot2_f32_bf16 v35, v137, v21, 0
  v_dot2_f32_bf16 v36, v138, v20, 0
  v_dot2_f32_bf16 v37, v138, v21, 0
  v_dot2_f32_bf16 v38, v139, v20, 0
  v_dot2_f32_bf16 v39, v139, v21, 0
  v_dot2c_f32_bf16 v24, v132, v22
  v_dot2c_f32_bf16 v25, v132, v23
  v_dot2c_f32_bf16 v26, v133, v22
  v_dot2c_f32_bf16 v27, v133, v23
  v_dot2c_f32_bf16 v28, v134, v22
  v_dot2c_f32_bf16 v29, v134, v23
  v_dot2c_f32_bf16 v30, v135, v22
  v_dot2c_f32_bf16 v31, v135, v23
  v_dot2c_f32_bf16 v32, v140, v22
  v_dot2c_f32_bf16 v33, v140, v23
  v_dot2c_f32_bf16 v34, v141, v22
  v_dot2c_f32_bf16 v35, v141, v23
  v_dot2c_f32_bf16 v36, v142, v22
  v_dot2c_f32_bf16 v37, v142, v23
  v_dot2c_f32_bf16 v38, v143, v22
  v_dot2c_f32_bf16 v39, v143, v23
  s_nop 2
  v_permlane32_swap_b32 v24, v32
  v_permlane32_swap_b32 v25, v33
  v_permlane32_swap_b32 v26, v34
  v_permlane32_swap_b32 v27, v35
  v_permlane32_swap_b32 v28, v36
  v_permlane32_swap_b32 v29, v37
  v_permlane32_swap_b32 v30, v38
  v_permlane32_swap_b32 v31, v39
  v_add_f32 v24, v24, v32
  v_add_f32 v25, v25, v33
  v_add_f32 v26, v26, v34
  v_add_f32 v27, v27, v35
  v_add_f32 v28, v28, v36
  v_add_f32 v29, v29, v37
  v_add_f32 v30, v30, v38
  v_add_f32 v31, v31, v39
  s_nop 0
  v_permlane16_swap_b32 v24, v28
  v_permlane16_swap_b32 v25, v29
  v_permlane16_swap_b32 v26, v30
  v_permlane16_swap_b32 v27, v31
  v_add_f32 v24, v24, v28
  v_add_f32 v25, v25, v29
  v_add_f32 v26, v26, v30
  v_add_f32 v27, v27, v31
  s_nop 1
  v_add_f32_dpp v24, v24, v24 row_ror:8 row_mask:0xf bank_mask:0x3
  v_add_f32_dpp v25, v25, v25 row_ror:8 row_mask:0xf bank_mask:0x3
  v_add_f32_dpp v24, v26, v26 row_ror:8 row_mask:0xf bank_mask:0xc
  v_add_f32_dpp v25, v27, v27 row_ror:8 row_mask:0xf bank_mask:0xc
  v_lshrrev_b32 v22, 5, v1
  v_lshlrev_b32 v22, 8, v22
  v_and_b32 v23, 7, v1
  v_lshl_add_u32 v22, v23, 5, v22
  v_bfe_u32 v23, v1, 4, 1
  v_lshl_add_u32 v22, v23, 4, v22
  v_bfe_u32 v23, v1, 3, 1
  v_lshl_add_u32 v22, v23, 3, v22
  s_lshl_b32 s73, s68, 9
  v_add_u32 v22, s73, v22
  ds_write_b64 v22, v[24:25] offset:12288
Lhv_31:
  s_lshl_b32 s73, s68, 11
  s_add_u32 s73, s73, 16384
  v_add_u32 v26, s73, v3
  s_nop 4
  s_mov_b64 exec, 0xffff
  ds_write_b128 v26, v[96:99] offset:0
  ds_write_b128 v26, v[100:103] offset:256
  ds_write_b128 v26, v[104:107] offset:512
  ds_write_b128 v26, v[108:111] offset:768
  ds_write_b128 v26, v[112:115] offset:1024
  ds_write_b128 v26, v[116:119] offset:1280
  ds_write_b128 v26, v[120:123] offset:1536
  ds_write_b128 v26, v[124:127] offset:1792
  s_mov_b64 exec, -1
  v_and_b32 v26, 3, v1
  v_lshlrev_b32 v26, 9, v26
  v_lshrrev_b32 v27, 2, v1
  v_lshl_add_u32 v26, v27, 4, v26
  s_lshl_b32 s73, s68, 2
  s_add_u32 s88, s73, 16384
  v_add_u32 v26, s88, v26
  v_mov_b32 v27, s73
  ds_read_b32 v80, v27 offset:9600
  ds_read_b32 v81, v27 offset:9616
  ds_read_b32 v82, v27 offset:9632
  ds_read_b32 v83, v27 offset:9648
  ds_read_b32 v84, v27 offset:9664
  ds_read_b32 v85, v27 offset:9680
  ds_read_b32 v86, v27 offset:9696
  ds_read_b32 v87, v27 offset:9712
  s_waitcnt lgkmcnt(0)
  s_barrier
  s_cmp_ge_u32 s68, 4
  s_cbranch_scc1 Lw_32
  ds_read2st64_b32 v[64:65], v26 offset0:0 offset1:1
  ds_read2st64_b32 v[66:67], v26 offset0:8 offset1:9
  ds_read2st64_b32 v[68:69], v26 offset0:16 offset1:17
  ds_read2st64_b32 v[70:71], v26 offset0:24 offset1:25
  ds_read2st64_b32 v[72:73], v26 offset0:32 offset1:33
  ds_read2st64_b32 v[74:75], v26 offset0:40 offset1:41
  ds_read2st64_b32 v[76:77], v26 offset0:48 offset1:49
  ds_read2st64_b32 v[78:79], v26 offset0:56 offset1:57
  s_lshl_b32 s73, s92, 12
  s_lshl_b32 s88, s68, 10
  s_add_u32 s73, s73, s88
  s_add_u32 s73, s73, 65536
  v_mov_b32 v29, s71
  v_mov_b32 v31, s71
  s_waitcnt lgkmcnt(0)
  v_mul_f32 v28, v64, v80
  v_mul_f32 v30, v65, v80
  v_mul_f32 v16, v66, v81
  v_mul_f32 v17, v67, v81
  v_fmac_f32 v28, v68, v82
  v_fmac_f32 v30, v69, v82
  v_fmac_f32 v16, v70, v83
  v_fmac_f32 v17, v71, v83
  v_fmac_f32 v28, v72, v84
  v_fmac_f32 v30, v73, v84
  v_fmac_f32 v16, v74, v85
  v_fmac_f32 v17, v75, v85
  v_fmac_f32 v28, v76, v86
  v_fmac_f32 v30, v77, v86
  v_fmac_f32 v16, v78, v87
  v_fmac_f32 v17, v79, v87
  v_add_f32 v28, v28, v16
  v_add_f32 v30, v30, v17
  buffer_store_dwordx4 v[28:31], v3, s[64:67], s73 offen sc1
Lw_32:
  s_cmp_ge_u32 s91, 128
  s_cbranch_scc1 L_light
  s_cmp_ge_u32 s91, 128
  s_cbranch_scc1 Lhv_33
  s_cmp_lg_u32 s68, 6
  s_cbranch_scc1 Lhv_33
  s_cmp_eq_u32 s95, 0
  s_cbranch_scc1 Lhv_33
  v_lshlrev_b32 v22, 3, v1
  ds_read_b64 v[16:17], v22 offset:12288
  ds_read_b64 v[18:19], v22 offset:12800
  ds_read_b64 v[20:21], v22 offset:13312
  ds_read_b64 v[28:29], v22 offset:13824
  ds_read_b64 v[56:57], v22 offset:14336
  ds_read_b64 v[58:59], v22 offset:14848
  ds_read_b64 v[60:61], v22 offset:15360
  ds_read_b64 v[62:63], v22 offset:15872
  s_waitcnt lgkmcnt(0)
  v_add_f32 v16, v16, v18
  v_add_f32 v20, v20, v28
  v_add_f32 v56, v56, v58
  v_add_f32 v60, v60, v62
  v_add_f32 v17, v17, v19
  v_add_f32 v21, v21, v29
  v_add_f32 v57, v57, v59
  v_add_f32 v61, v61, v63
  v_add_f32 v16, v16, v20
  v_add_f32 v56, v56, v60
  v_add_f32 v17, v17, v21
  v_add_f32 v57, v57, v61
  v_add_f32 v24, v16, v56
  v_add_f32 v26, v17, v57
  v_mov_b32 v25, s71
  v_mov_b32 v27, s71
  s_lshl_b32 s73, s79, 10
  s_add_u32 s73, s73, 2097152
  buffer_store_dwordx4 v[24:27], v3, s[64:67], s73 offen sc1
Lhv_33:
  s_waitcnt vmcnt(0)
  s_barrier
  s_cmp_ge_u32 s68, 4
  s_cbranch_scc1 Lhi_34
  s_lshl_b32 s88, s68, 8
  s_add_u32 s88, s88, 32768
  v_add_u32 v9, s88, v13
  ds_read_b32 v128, v9 offset:0
  ds_read_b32 v129, v9 offset:1024
  ds_read_b32 v130, v9 offset:2048
  ds_read_b32 v131, v9 offset:3072
  ds_read_b32 v132, v9 offset:4096
  ds_read_b32 v133, v9 offset:5120
  ds_read_b32 v134, v9 offset:6144
  ds_read_b32 v135, v9 offset:7168
  ds_read_b32 v136, v9 offset:8192
  ds_read_b32 v137, v9 offset:9216
  ds_read_b32 v138, v9 offset:10240
  ds_read_b32 v139, v9 offset:11264
  ds_read_b32 v140, v9 offset:12288
  ds_read_b32 v141, v9 offset:13312
  ds_read_b32 v142, v9 offset:14336
  ds_read_b32 v143, v9 offset:15360
  ds_read_b32 v144, v9 offset:16384
  ds_read_b32 v145, v9 offset:17408
  ds_read_b32 v146, v9 offset:18432
  ds_read_b32 v147, v9 offset:19456
  ds_read_b32 v148, v9 offset:20480
  ds_read_b32 v149, v9 offset:21504
  ds_read_b32 v150, v9 offset:22528
  ds_read_b32 v151, v9 offset:23552
  ds_read_b32 v152, v9 offset:24576
  ds_read_b32 v153, v9 offset:25600
  ds_read_b32 v154, v9 offset:26624
  ds_read_b32 v155, v9 offset:27648
  ds_read_b32 v156, v9 offset:28672
  ds_read_b32 v157, v9 offset:29696
  ds_read_b32 v158, v9 offset:30720
  ds_read_b32 v159, v9 offset:31744
  s_waitcnt lgkmcnt(0)
  v_lshlrev_b32 v160, 16, v128
  v_and_b32 v161, s78, v128
  v_lshlrev_b32 v162, 16, v129
  v_and_b32 v163, s78, v129
  v_lshlrev_b32 v164, 16, v130
  v_and_b32 v165, s78, v130
  v_lshlrev_b32 v166, 16, v131
  v_and_b32 v167, s78, v131
  v_lshlrev_b32 v168, 16, v132
  v_and_b32 v169, s78, v132
  v_lshlrev_b32 v170, 16, v133
  v_and_b32 v171, s78, v133
  v_lshlrev_b32 v172, 16, v134
  v_and_b32 v173, s78, v134
  v_lshlrev_b32 v174, 16, v135
  v_and_b32 v175, s78, v135
  v_lshlrev_b32 v176, 16, v136
  v_and_b32 v177, s78, v136
  v_lshlrev_b32 v178, 16, v137
  v_and_b32 v179, s78, v137
  v_lshlrev_b32 v180, 16, v138
  v_and_b32 v181, s78, v138
  v_lshlrev_b32 v182, 16, v139
  v_and_b32 v183, s78, v139
  v_lshlrev_b32 v184, 16, v140
  v_and_b32 v185, s78, v140
  v_lshlrev_b32 v186, 16, v141
  v_and_b32 v187, s78, v141
  v_lshlrev_b32 v188, 16, v142
  v_and_b32 v189, s78, v142
  v_lshlrev_b32 v190, 16, v143
  v_and_b32 v191, s78, v143
  v_lshlrev_b32 v192, 16, v144
  v_and_b32 v193, s78, v144
  v_lshlrev_b32 v194, 16, v145
  v_and_b32 v195, s78, v145
  v_lshlrev_b32 v196, 16, v146
  v_and_b32 v197, s78, v146
  v_lshlrev_b32 v198, 16, v147
  v_and_b32 v199, s78, v147
  v_lshlrev_b32 v200, 16, v148
  v_and_b32 v201, s78, v148
  v_lshlrev_b32 v202, 16, v149
  v_and_b32 v203, s78, v149
  v_lshlrev_b32 v204, 16, v150
  v_and_b32 v205, s78, v150
  v_lshlrev_b32 v206, 16, v151
  v_and_b32 v207, s78, v151
  v_lshlrev_b32 v208, 16, v152
  v_and_b32 v209, s78, v152
  v_lshlrev_b32 v210, 16, v153
  v_and_b32 v211, s78, v153
  v_lshlrev_b32 v212, 16, v154
  v_and_b32 v213, s78, v154
  v_lshlrev_b32 v214, 16, v155
  v_and_b32 v215, s78, v155
  v_lshlrev_b32 v216, 16, v156
  v_and_b32 v217, s78, v156
  v_lshlrev_b32 v218, 16, v157
  v_and_b32 v219, s78, v157
  v_lshlrev_b32 v220, 16, v158
  v_and_b32 v221, s78, v158
  v_lshlrev_b32 v222, 16, v159
  v_and_b32 v223, s78, v159
  s_cmp_lg_u32 s68, 3
  s_cbranch_scc1 Lsp_35
  s_nop 1
  v_lshrrev_b32 v26, 4, v1
  v_lshlrev_b32 v26, 12, v26
  v_and_b32 v28, 15, v1
  v_lshl_add_u32 v26, v28, 4, v26
  s_lshr_b32 s73, s91, 4
  s_lshl_b32 s73, s73, 17
  s_and_b32 s88, s91, 15
  s_lshl_b32 s88, s88, 8
  s_add_u32 s73, s73, s88
  s_add_u32 s73, s73, 65536
  s_mov_b32 s90, 0
  s_mov_b32 s94, 0
Lps_37:
  s_add_u32 s94, s94, 1
  s_cmp_gt_u32 s94, 262144
  s_cbranch_scc1 L_end
  s_bitcmp1_b32 s90, 0
  s_cbranch_scc1 Lpk_40
  s_add_u32 s88, s73, 0
  buffer_load_dwordx4 v[64:67], v26, s[64:67], s88 offen sc1
Lpk_40:
  s_bitcmp1_b32 s90, 1
  s_cbranch_scc1 Lpk_41
  s_add_u32 s88, s73, 16384
  buffer_load_dwordx4 v[68:71], v26, s[64:67], s88 offen sc1
Lpk_41:
  s_bitcmp1_b32 s90, 2
  s_cbranch_scc1 Lpk_42
  s_add_u32 s88, s73, 32768
  buffer_load_dwordx4 v[72:75], v26, s[64:67], s88 offen sc1
Lpk_42:
  s_bitcmp1_b32 s90, 3
  s_cbranch_scc1 Lpk_43
  s_add_u32 s88, s73, 49152
  buffer_load_dwordx4 v[76:79], v26, s[64:67], s88 offen sc1
Lpk_43:
  s_bitcmp1_b32 s90, 4
  s_cbranch_scc1 Lpk_44
  s_add_u32 s88, s73, 65536
  buffer_load_dwordx4 v[80:83], v26, s[64:67], s88 offen sc1
Lpk_44:
  s_bitcmp1_b32 s90, 5
  s_cbranch_scc1 Lpk_45
  s_add_u32 s88, s73, 81920
  buffer_load_dwordx4 v[84:87], v26, s[64:67], s88 offen sc1
Lpk_45:
  s_bitcmp1_b32 s90, 6
  s_cbranch_scc1 Lpk_46
  s_add_u32 s88, s73, 98304
  buffer_load_dwordx4 v[88:91], v26, s[64:67], s88 offen sc1
Lpk_46:
  s_bitcmp1_b32 s90, 7
  s_cbranch_scc1 Lpk_47
  s_add_u32 s88, s73, 114688
  buffer_load_dwordx4 v[92:95], v26, s[64:67], s88 offen sc1
Lpk_47:
  s_waitcnt vmcnt(0)
  v_xor_b32 v24, s71, v65
  v_xor_b32 v25, s71, v67
  v_or_b32 v24, v24, v25
  v_xor_b32 v25, s71, v69
  v_or_b32 v24, v24, v25
  v_xor_b32 v25, s71, v71
  v_or_b32 v24, v24, v25
  v_xor_b32 v25, s71, v73
  v_or_b32 v24, v24, v25
  v_xor_b32 v25, s71, v75
  v_or_b32 v24, v24, v25
  v_xor_b32 v25, s71, v77
  v_or_b32 v24, v24, v25
  v_xor_b32 v25, s71, v79
  v_or_b32 v24, v24, v25
  v_xor_b32 v25, s71, v81
  v_or_b32 v24, v24, v25
  v_xor_b32 v25, s71, v83
  v_or_b32 v24, v24, v25
  v_xor_b32 v25, s71, v85
  v_or_b32 v24, v24, v25
  v_xor_b32 v25, s71, v87
  v_or_b32 v24, v24, v25
  v_xor_b32 v25, s71, v89
  v_or_b32 v24, v24, v25
  v_xor_b32 v25, s71, v91
  v_or_b32 v24, v24, v25
  v_xor_b32 v25, s71, v93
  v_or_b32 v24, v24, v25
  v_xor_b32 v25, s71, v95
  v_or_b32 v24, v24, v25
  v_cmp_ne_u32 vcc, 0, v24
  s_cmp_lg_u64 vcc, 0
  s_cbranch_scc1 Lpb_39
  s_branch Lpd_38
Lpb_39:
  s_bitcmp1_b32 s90, 0
  s_cbranch_scc1 Lpu_48
  v_xor_b32 v24, s71, v65
  v_xor_b32 v25, s71, v67
  v_or_b32 v24, v24, v25
  v_cmp_ne_u32 vcc, 0, v24
  s_cmp_eq_u64 vcc, 0
  s_cselect_b32 s98, 1, 0
  s_or_b32 s90, s90, s98
Lpu_48:
  s_bitcmp1_b32 s90, 1
  s_cbranch_scc1 Lpu_49
  v_xor_b32 v24, s71, v69
  v_xor_b32 v25, s71, v71
  v_or_b32 v24, v24, v25
  v_cmp_ne_u32 vcc, 0, v24
  s_cmp_eq_u64 vcc, 0
  s_cselect_b32 s98, 2, 0
  s_or_b32 s90, s90, s98
Lpu_49:
  s_bitcmp1_b32 s90, 2
  s_cbranch_scc1 Lpu_50
  v_xor_b32 v24, s71, v73
  v_xor_b32 v25, s71, v75
  v_or_b32 v24, v24, v25
  v_cmp_ne_u32 vcc, 0, v24
  s_cmp_eq_u64 vcc, 0
  s_cselect_b32 s98, 4, 0
  s_or_b32 s90, s90, s98
Lpu_50:
  s_bitcmp1_b32 s90, 3
  s_cbranch_scc1 Lpu_51
  v_xor_b32 v24, s71, v77
  v_xor_b32 v25, s71, v79
  v_or_b32 v24, v24, v25
  v_cmp_ne_u32 vcc, 0, v24
  s_cmp_eq_u64 vcc, 0
  s_cselect_b32 s98, 8, 0
  s_or_b32 s90, s90, s98
Lpu_51:
  s_bitcmp1_b32 s90, 4
  s_cbranch_scc1 Lpu_52
  v_xor_b32 v24, s71, v81
  v_xor_b32 v25, s71, v83
  v_or_b32 v24, v24, v25
  v_cmp_ne_u32 vcc, 0, v24
  s_cmp_eq_u64 vcc, 0
  s_cselect_b32 s98, 16, 0
  s_or_b32 s90, s90, s98
Lpu_52:
  s_bitcmp1_b32 s90, 5
  s_cbranch_scc1 Lpu_53
  v_xor_b32 v24, s71, v85
  v_xor_b32 v25, s71, v87
  v_or_b32 v24, v24, v25
  v_cmp_ne_u32 vcc, 0, v24
  s_cmp_eq_u64 vcc, 0
  s_cselect_b32 s98, 32, 0
  s_or_b32 s90, s90, s98
Lpu_53:
  s_bitcmp1_b32 s90, 6
  s_cbranch_scc1 Lpu_54
  v_xor_b32 v24, s71, v89
  v_xor_b32 v25, s71, v91
  v_or_b32 v24, v24, v25
  v_cmp_ne_u32 vcc, 0, v24
  s_cmp_eq_u64 vcc, 0
  s_cselect_b32 s98, 64, 0
  s_or_b32 s90, s90, s98
Lpu_54:
  s_bitcmp1_b32 s90, 7
  s_cbranch_scc1 Lpu_55
  v_xor_b32 v24, s71, v93
  v_xor_b32 v25, s71, v95
  v_or_b32 v24, v24, v25
  v_cmp_ne_u32 vcc, 0, v24
  s_cmp_eq_u64 vcc, 0
  s_cselect_b32 s98, 128, 0
  s_or_b32 s90, s90, s98
Lpu_55:
  s_branch Lps_37
Lpd_38:
  v_add_f32 v64, v64, v68
  v_add_f32 v72, v72, v76
  v_add_f32 v80, v80, v84
  v_add_f32 v88, v88, v92
  v_add_f32 v66, v66, v70
  v_add_f32 v74, v74, v78
  v_add_f32 v82, v82, v86
  v_add_f32 v90, v90, v94
  v_add_f32 v64, v64, v72
  v_add_f32 v80, v80, v88
  v_add_f32 v66, v66, v74
  v_add_f32 v82, v82, v90
  v_add_f32 v64, v64, v80
  v_add_f32 v66, v66, v82
  s_nop 0
  v_mov_b32 v24, v64
  v_mov_b32 v25, v66
  s_nop 0
  s_nop 0
  v_permlane16_swap_b32 v64, v24
  v_permlane16_swap_b32 v66, v25
  v_add_f32 v64, v64, v24
  v_add_f32 v66, v66, v25
  v_mov_b32 v24, v64
  v_mov_b32 v25, v66
  s_nop 0
  s_nop 0
  v_permlane32_swap_b32 v64, v24
  v_permlane32_swap_b32 v66, v25
  v_add_f32 v64, v64, v24
  v_add_f32 v66, v66, v25
  v_cvt_pk_bf16_f32 v24, v64, v66
  v_lshlrev_b32 v64, 16, v24
  v_and_b32 v65, s78, v24
  v_and_b32 v26, 15, v1
  v_lshlrev_b32 v26, 3, v26
  ds_write_b64 v26, v[64:65] offset:9472
  s_waitcnt lgkmcnt(0)
  s_or_b32 s88, s71, 1
  v_mov_b32 v24, 0
  v_mov_b32 v25, s88
  ds_write_b32 v24, v25 offset:11264
  s_branch Lgo_36
Lsp_35:
  s_mov_b32 s94, 0
  v_mov_b32 v24, 0
  s_or_b32 s73, s71, 1
Lspin_56:
  s_add_u32 s94, s94, 1
  s_cmp_gt_u32 s94, 2097152
  s_cbranch_scc1 L_end
  ds_read_b32 v25, v24 offset:11264
  s_waitcnt lgkmcnt(0)
  v_readfirstlane_b32 s88, v25
  s_cmp_lg_u32 s88, s73
  s_cbranch_scc1 Lspin_56
Lgo_36:
  s_lshl_b32 s73, s91, 12
  s_lshl_b32 s88, s68, 10
  s_add_u32 s73, s73, s88
  s_add_u32 s73, s73, 1114112
  v_mov_b32 v24, 0
  ds_read_b128 v[64:67], v24 offset:9472
  ds_read_b128 v[68:71], v24 offset:9488
  ds_read_b128 v[72:75], v24 offset:9504
  ds_read_b128 v[76:79], v24 offset:9520
  ds_read_b128 v[80:83], v24 offset:9536
  ds_read_b128 v[84:87], v24 offset:9552
  ds_read_b128 v[88:91], v24 offset:9568
  ds_read_b128 v[92:95], v24 offset:9584
  v_mov_b32 v29, s71
  v_mov_b32 v31, s71
  s_waitcnt lgkmcnt(7)
  v_mul_f32 v28, v64, v160
  v_mul_f32 v30, v64, v161
  v_mul_f32 v32, v65, v162
  v_mul_f32 v33, v65, v163
  v_fmac_f32 v28, v66, v164
  v_fmac_f32 v30, v66, v165
  v_fmac_f32 v32, v67, v166
  v_fmac_f32 v33, v67, v167
  s_waitcnt lgkmcnt(6)
  v_fmac_f32 v28, v68, v168
  v_fmac_f32 v30, v68, v169
  v_fmac_f32 v32, v69, v170
  v_fmac_f32 v33, v69, v171
  v_fmac_f32 v28, v70, v172
  v_fmac_f32 v30, v70, v173
  v_fmac_f32 v32, v71, v174
  v_fmac_f32 v33, v71, v175
  s_waitcnt lgkmcnt(5)
  v_fmac_f32 v28, v72, v176
  v_fmac_f32 v30, v72, v177
  v_fmac_f32 v32, v73, v178
  v_fmac_f32 v33, v73, v179
  v_fmac_f32 v28, v74, v180
  v_fmac_f32 v30, v74, v181
  v_fmac_f32 v32, v75, v182
  v_fmac_f32 v33, v75, v183
  s_waitcnt lgkmcnt(4)
  v_fmac_f32 v28, v76, v184
  v_fmac_f32 v30, v76, v185
  v_fmac_f32 v32, v77, v186
  v_fmac_f32 v33, v77, v187
  v_fmac_f32 v28, v78, v188
  v_fmac_f32 v30, v78, v189
  v_fmac_f32 v32, v79, v190
  v_fmac_f32 v33, v79, v191
  s_waitcnt lgkmcnt(3)
  v_fmac_f32 v28, v80, v192
  v_fmac_f32 v30, v80, v193
  v_fmac_f32 v32, v81, v194
  v_fmac_f32 v33, v81, v195
  v_fmac_f32 v28, v82, v196
  v_fmac_f32 v30, v82, v197
  v_fmac_f32 v32, v83, v198
  v_fmac_f32 v33, v83, v199
  s_waitcnt lgkmcnt(2)
  v_fmac_f32 v28, v84, v200
  v_fmac_f32 v30, v84, v201
  v_fmac_f32 v32, v85, v202
  v_fmac_f32 v33, v85, v203
  v_fmac_f32 v28, v86, v204
  v_fmac_f32 v30, v86, v205
  v_fmac_f32 v32, v87, v206
  v_fmac_f32 v33, v87, v207
  s_waitcnt lgkmcnt(1)
  v_fmac_f32 v28, v88, v208
  v_fmac_f32 v30, v88, v209
  v_fmac_f32 v32, v89, v210
  v_fmac_f32 v33, v89, v211
  v_fmac_f32 v28, v90, v212
  v_fmac_f32 v30, v90, v213
  v_fmac_f32 v32, v91, v214
  v_fmac_f32 v33, v91, v215
  s_waitcnt lgkmcnt(0)
  v_fmac_f32 v28, v92, v216
  v_fmac_f32 v30, v92, v217
  v_fmac_f32 v32, v93, v218
  v_fmac_f32 v33, v93, v219
  v_fmac_f32 v28, v94, v220
  v_fmac_f32 v30, v94, v221
  v_fmac_f32 v32, v95, v222
  v_fmac_f32 v33, v95, v223
  v_add_f32 v28, v28, v32
  v_add_f32 v30, v30, v33
  buffer_store_dwordx4 v[28:31], v3, s[64:67], s73 offen sc1
  s_branch L_end
Lhi_34:
  s_cmp_eq_u32 s95, 0
  s_cbranch_scc1 L_end
  s_mov_b32 s94, 0
Lgp_58:
  s_add_u32 s94, s94, 1
  s_cmp_gt_u32 s94, 262144
  s_cbranch_scc1 L_end
  v_lshrrev_b32 v9, 4, v1
  v_lshlrev_b32 v9, 10, v9
  v_bfe_u32 v15, v1, 3, 1
  v_lshl_add_u32 v9, v15, 9, v9
  v_and_b32 v15, 7, v1
  v_lshl_add_u32 v9, v15, 4, v9
  s_lshr_b32 s73, s79, 2
  s_lshl_b32 s73, s73, 12
  s_and_b32 s88, s79, 3
  s_lshl_b32 s88, s88, 7
  s_add_u32 s73, s73, s88
  s_add_u32 s73, s73, 2097152
  buffer_load_dwordx4 v[32:35], v9, s[64:67], s73 offen sc1
  s_waitcnt vmcnt(0)
  v_xor_b32 v24, s71, v33
  v_xor_b32 v25, s71, v35
  v_or_b32 v24, v24, v25
  v_cmp_ne_u32 vcc, 0, v24
  s_cmp_lg_u64 vcc, 0
  s_cbranch_scc1 Lgp_58
  s_sub_u32 s88, s68, 4
  s_lshl_b32 s88, s88, 8
  v_add_u32 v9, s88, v13
  v_add_u32 v9, 65536, v9
  ds_read_b32 v40, v9 offset:0
  ds_read_b32 v41, v9 offset:1024
  ds_read_b32 v42, v9 offset:2048
  ds_read_b32 v43, v9 offset:3072
  ds_read_b32 v44, v9 offset:4096
  ds_read_b32 v45, v9 offset:5120
  ds_read_b32 v46, v9 offset:6144
  ds_read_b32 v47, v9 offset:7168
  ds_read_b32 v48, v9 offset:8192
  ds_read_b32 v49, v9 offset:9216
  ds_read_b32 v50, v9 offset:10240
  ds_read_b32 v51, v9 offset:11264
  ds_read_b32 v52, v9 offset:12288
  ds_read_b32 v53, v9 offset:13312
  ds_read_b32 v54, v9 offset:14336
  ds_read_b32 v55, v9 offset:15360
  v_mov_b32 v24, v32
  v_mov_b32 v25, v34
  s_nop 0
  s_nop 0
  v_permlane16_swap_b32 v32, v24
  v_permlane16_swap_b32 v34, v25
  v_add_f32 v32, v32, v24
  v_add_f32 v34, v34, v25
  v_mov_b32 v24, v32
  v_mov_b32 v25, v34
  s_nop 0
  s_nop 0
  v_permlane32_swap_b32 v32, v24
  v_permlane32_swap_b32 v34, v25
  v_add_f32 v32, v32, v24
  v_add_f32 v34, v34, v25
  v_cvt_pk_bf16_f32 v24, v32, v34
  v_lshlrev_b32 v32, 16, v24
  v_and_b32 v34, s78, v24
  v_mul_f32 v26, v32, v32
  v_mul_f32 v27, v34, v34
  v_mul_f32 v26, v26, v32
  v_mul_f32 v27, v27, v34
  v_mov_b32 v28, 0x3d372713
  v_fma_f32 v26, v26, v28, v32
  v_fma_f32 v27, v27, v28, v34
  v_mul_f32 v26, 0xc0135761, v26
  v_mul_f32 v27, 0xc0135761, v27
  v_exp_f32 v26, v26
  v_exp_f32 v27, v27
  s_nop 0
  v_add_f32 v26, 1.0, v26
  v_add_f32 v27, 1.0, v27
  v_rcp_f32 v26, v26
  v_rcp_f32 v27, v27
  s_nop 0
  v_mul_f32 v26, v32, v26
  v_mul_f32 v27, v34, v27
  v_cvt_pk_bf16_f32 v24, v26, v27
  v_lshlrev_b32 v26, 16, v24
  v_and_b32 v27, s78, v24
  v_mov_b32_dpp v28, v32 row_shl:8 row_mask:0xf bank_mask:0xf
  v_mov_b32_dpp v29, v34 row_shl:8 row_mask:0xf bank_mask:0xf
  v_mul_f32 v26, v26, v28
  v_mul_f32 v27, v27, v29
  v_cvt_pk_bf16_f32 v24, v26, v27
  v_lshlrev_b32 v26, 16, v24
  v_and_b32 v27, s78, v24
  s_nop 0
  v_readlane_b32 s4, v26, 0
  v_readlane_b32 s5, v27, 0
  v_readlane_b32 s6, v26, 1
  v_readlane_b32 s7, v27, 1
  v_readlane_b32 s8, v26, 2
  v_readlane_b32 s9, v27, 2
  v_readlane_b32 s10, v26, 3
  v_readlane_b32 s11, v27, 3
  v_readlane_b32 s12, v26, 4
  v_readlane_b32 s13, v27, 4
  v_readlane_b32 s14, v26, 5
  v_readlane_b32 s15, v27, 5
  v_readlane_b32 s16, v26, 6
  v_readlane_b32 s17, v27, 6
  v_readlane_b32 s18, v26, 7
  v_readlane_b32 s19, v27, 7
  v_mov_b32 v24, 0
  v_mov_b32 v26, 0
  v_mov_b32 v30, 0
  v_mov_b32 v31, 0
  s_waitcnt lgkmcnt(0)
  v_lshlrev_b32 v28, 16, v40
  v_and_b32 v29, s78, v40
  v_fmac_f32 v24, s4, v28
  v_fmac_f32 v26, s4, v29
  v_lshlrev_b32 v28, 16, v41
  v_and_b32 v29, s78, v41
  v_fmac_f32 v30, s5, v28
  v_fmac_f32 v31, s5, v29
  v_lshlrev_b32 v28, 16, v42
  v_and_b32 v29, s78, v42
  v_fmac_f32 v24, s6, v28
  v_fmac_f32 v26, s6, v29
  v_lshlrev_b32 v28, 16, v43
  v_and_b32 v29, s78, v43
  v_fmac_f32 v30, s7, v28
  v_fmac_f32 v31, s7, v29
  v_lshlrev_b32 v28, 16, v44
  v_and_b32 v29, s78, v44
  v_fmac_f32 v24, s8, v28
  v_fmac_f32 v26, s8, v29
  v_lshlrev_b32 v28, 16, v45
  v_and_b32 v29, s78, v45
  v_fmac_f32 v30, s9, v28
  v_fmac_f32 v31, s9, v29
  v_lshlrev_b32 v28, 16, v46
  v_and_b32 v29, s78, v46
  v_fmac_f32 v24, s10, v28
  v_fmac_f32 v26, s10, v29
  v_lshlrev_b32 v28, 16, v47
  v_and_b32 v29, s78, v47
  v_fmac_f32 v30, s11, v28
  v_fmac_f32 v31, s11, v29
  v_lshlrev_b32 v28, 16, v48
  v_and_b32 v29, s78, v48
  v_fmac_f32 v24, s12, v28
  v_fmac_f32 v26, s12, v29
  v_lshlrev_b32 v28, 16, v49
  v_and_b32 v29, s78, v49
  v_fmac_f32 v30, s13, v28
  v_fmac_f32 v31, s13, v29
  v_lshlrev_b32 v28, 16, v50
  v_and_b32 v29, s78, v50
  v_fmac_f32 v24, s14, v28
  v_fmac_f32 v26, s14, v29
  v_lshlrev_b32 v28, 16, v51
  v_and_b32 v29, s78, v51
  v_fmac_f32 v30, s15, v28
  v_fmac_f32 v31, s15, v29
  v_lshlrev_b32 v28, 16, v52
  v_and_b32 v29, s78, v52
  v_fmac_f32 v24, s16, v28
  v_fmac_f32 v26, s16, v29
  v_lshlrev_b32 v28, 16, v53
  v_and_b32 v29, s78, v53
  v_fmac_f32 v30, s17, v28
  v_fmac_f32 v31, s17, v29
  v_lshlrev_b32 v28, 16, v54
  v_and_b32 v29, s78, v54
  v_fmac_f32 v24, s18, v28
  v_fmac_f32 v26, s18, v29
  v_lshlrev_b32 v28, 16, v55
  v_and_b32 v29, s78, v55
  v_fmac_f32 v30, s19, v28
  v_fmac_f32 v31, s19, v29
  v_add_f32 v24, v24, v30
  v_add_f32 v26, v26, v31
  v_mov_b32 v25, s71
  v_mov_b32 v27, s71
  s_lshl_b32 s73, s79, 12
  s_sub_u32 s88, s68, 4
  s_lshl_b32 s88, s88, 10
  s_add_u32 s73, s73, s88
  s_add_u32 s73, s73, 1638400
  buffer_store_dwordx4 v[24:27], v3, s[64:67], s73 offen sc1
  s_branch L_end
L_light:
  s_cmp_ge_u32 s91, 192
  s_cbranch_scc1 L_end
  s_sub_u32 s91, s91, 128
  s_cmp_lg_u32 s68, 7
  s_cbranch_scc1 L_end
  v_lshrrev_b32 v8, 2, v1
  v_lshlrev_b32 v8, 12, v8
  v_and_b32 v26, 3, v1
  v_lshl_add_u32 v8, v26, 4, v8
  s_lshl_b32 s99, s91, 6
  v_lshlrev_b32 v29, 2, v26
  s_lshl_b32 s73, s91, 4
  buffer_load_dword v12, v29, s[56:59], s73 offen
  s_mov_b32 s90, 0
  s_mov_b32 s94, 0
Lps_59:
  s_add_u32 s94, s94, 1
  s_cmp_gt_u32 s94, 262144
  s_cbranch_scc1 L_end
  s_bitcmp1_b32 s90, 0
  s_cbranch_scc1 Lpk_62
  s_add_u32 s88, s99, 1638400
  buffer_load_dwordx4 v[96:99], v8, s[64:67], s88 offen sc1
Lpk_62:
  s_bitcmp1_b32 s90, 1
  s_cbranch_scc1 Lpk_63
  s_add_u32 s88, s99, 1703936
  buffer_load_dwordx4 v[100:103], v8, s[64:67], s88 offen sc1
Lpk_63:
  s_bitcmp1_b32 s90, 2
  s_cbranch_scc1 Lpk_64
  s_add_u32 s88, s99, 1769472
  buffer_load_dwordx4 v[104:107], v8, s[64:67], s88 offen sc1
Lpk_64:
  s_bitcmp1_b32 s90, 3
  s_cbranch_scc1 Lpk_65
  s_add_u32 s88, s99, 1835008
  buffer_load_dwordx4 v[108:111], v8, s[64:67], s88 offen sc1
Lpk_65:
  s_bitcmp1_b32 s90, 4
  s_cbranch_scc1 Lpk_66
  s_add_u32 s88, s99, 1900544
  buffer_load_dwordx4 v[112:115], v8, s[64:67], s88 offen sc1
Lpk_66:
  s_bitcmp1_b32 s90, 5
  s_cbranch_scc1 Lpk_67
  s_add_u32 s88, s99, 1966080
  buffer_load_dwordx4 v[116:119], v8, s[64:67], s88 offen sc1
Lpk_67:
  s_bitcmp1_b32 s90, 6
  s_cbranch_scc1 Lpk_68
  s_add_u32 s88, s99, 2031616
  buffer_load_dwordx4 v[120:123], v8, s[64:67], s88 offen sc1
Lpk_68:
  s_waitcnt vmcnt(0)
  v_xor_b32 v24, s71, v97
  v_xor_b32 v25, s71, v99
  v_or_b32 v24, v24, v25
  v_xor_b32 v25, s71, v101
  v_or_b32 v24, v24, v25
  v_xor_b32 v25, s71, v103
  v_or_b32 v24, v24, v25
  v_xor_b32 v25, s71, v105
  v_or_b32 v24, v24, v25
  v_xor_b32 v25, s71, v107
  v_or_b32 v24, v24, v25
  v_xor_b32 v25, s71, v109
  v_or_b32 v24, v24, v25
  v_xor_b32 v25, s71, v111
  v_or_b32 v24, v24, v25
  v_xor_b32 v25, s71, v113
  v_or_b32 v24, v24, v25
  v_xor_b32 v25, s71, v115
  v_or_b32 v24, v24, v25
  v_xor_b32 v25, s71, v117
  v_or_b32 v24, v24, v25
  v_xor_b32 v25, s71, v119
  v_or_b32 v24, v24, v25
  v_xor_b32 v25, s71, v121
  v_or_b32 v24, v24, v25
  v_xor_b32 v25, s71, v123
  v_or_b32 v24, v24, v25
  v_cmp_ne_u32 vcc, 0, v24
  s_cmp_lg_u64 vcc, 0
  s_cbranch_scc1 Lpb_61
  s_branch Lpd_60
Lpb_61:
  s_bitcmp1_b32 s90, 0
  s_cbranch_scc1 Lpu_69
  v_xor_b32 v24, s71, v97
  v_xor_b32 v25, s71, v99
  v_or_b32 v24, v24, v25
  v_cmp_ne_u32 vcc, 0, v24
  s_cmp_eq_u64 vcc, 0
  s_cselect_b32 s98, 1, 0
  s_or_b32 s90, s90, s98
Lpu_69:
  s_bitcmp1_b32 s90, 1
  s_cbranch_scc1 Lpu_70
  v_xor_b32 v24, s71, v101
  v_xor_b32 v25, s71, v103
  v_or_b32 v24, v24, v25
  v_cmp_ne_u32 vcc, 0, v24
  s_cmp_eq_u64 vcc, 0
  s_cselect_b32 s98, 2, 0
  s_or_b32 s90, s90, s98
Lpu_70:
  s_bitcmp1_b32 s90, 2
  s_cbranch_scc1 Lpu_71
  v_xor_b32 v24, s71, v105
  v_xor_b32 v25, s71, v107
  v_or_b32 v24, v24, v25
  v_cmp_ne_u32 vcc, 0, v24
  s_cmp_eq_u64 vcc, 0
  s_cselect_b32 s98, 4, 0
  s_or_b32 s90, s90, s98
Lpu_71:
  s_bitcmp1_b32 s90, 3
  s_cbranch_scc1 Lpu_72
  v_xor_b32 v24, s71, v109
  v_xor_b32 v25, s71, v111
  v_or_b32 v24, v24, v25
  v_cmp_ne_u32 vcc, 0, v24
  s_cmp_eq_u64 vcc, 0
  s_cselect_b32 s98, 8, 0
  s_or_b32 s90, s90, s98
Lpu_72:
  s_bitcmp1_b32 s90, 4
  s_cbranch_scc1 Lpu_73
  v_xor_b32 v24, s71, v113
  v_xor_b32 v25, s71, v115
  v_or_b32 v24, v24, v25
  v_cmp_ne_u32 vcc, 0, v24
  s_cmp_eq_u64 vcc, 0
  s_cselect_b32 s98, 16, 0
  s_or_b32 s90, s90, s98
Lpu_73:
  s_bitcmp1_b32 s90, 5
  s_cbranch_scc1 Lpu_74
  v_xor_b32 v24, s71, v117
  v_xor_b32 v25, s71, v119
  v_or_b32 v24, v24, v25
  v_cmp_ne_u32 vcc, 0, v24
  s_cmp_eq_u64 vcc, 0
  s_cselect_b32 s98, 32, 0
  s_or_b32 s90, s90, s98
Lpu_74:
  s_bitcmp1_b32 s90, 6
  s_cbranch_scc1 Lpu_75
  v_xor_b32 v24, s71, v121
  v_xor_b32 v25, s71, v123
  v_or_b32 v24, v24, v25
  v_cmp_ne_u32 vcc, 0, v24
  s_cmp_eq_u64 vcc, 0
  s_cselect_b32 s98, 64, 0
  s_or_b32 s90, s90, s98
Lpu_75:
  s_branch Lps_59
Lpd_60:
  v_add_f32 v96, v96, v100
  v_add_f32 v104, v104, v108
  v_add_f32 v112, v112, v116
  v_add_f32 v98, v98, v102
  v_add_f32 v106, v106, v110
  v_add_f32 v114, v114, v118
  v_add_f32 v96, v96, v104
  v_add_f32 v112, v112, v120
  v_add_f32 v98, v98, v106
  v_add_f32 v114, v114, v122
  v_add_f32 v96, v96, v112
  v_add_f32 v98, v98, v114
  s_nop 0
  s_nop 0
  v_add_f32_dpp v96, v96, v96 row_ror:4 row_mask:0xf bank_mask:0xf
  v_add_f32_dpp v98, v98, v98 row_ror:4 row_mask:0xf bank_mask:0xf
  s_nop 0
  v_add_f32_dpp v96, v96, v96 row_ror:8 row_mask:0xf bank_mask:0xf
  v_add_f32_dpp v98, v98, v98 row_ror:8 row_mask:0xf bank_mask:0xf
  v_mov_b32 v24, v96
  v_mov_b32 v25, v98
  s_nop 0
  s_nop 0
  v_permlane16_swap_b32 v96, v24
  v_permlane16_swap_b32 v98, v25
  v_add_f32 v96, v96, v24
  v_add_f32 v98, v98, v25
  v_mov_b32 v24, v96
  v_mov_b32 v25, v98
  s_nop 0
  s_nop 0
  v_permlane32_swap_b32 v96, v24
  v_permlane32_swap_b32 v98, v25
  v_add_f32 v96, v96, v24
  v_add_f32 v98, v98, v25
  v_cvt_pk_bf16_f32 v33, v96, v98
  v_lshlrev_b32 v96, 16, v33
  v_and_b32 v97, s78, v33
  v_mul_f32 v28, 0xbfb8aa3b, v96
  v_mul_f32 v29, 0xbfb8aa3b, v97
  v_exp_f32 v28, v28
  v_exp_f32 v29, v29
  v_lshlrev_b32 v16, 16, v12
  v_and_b32 v17, s78, v12
  v_lshlrev_b32 v18, 2, v26
  v_add_f32 v28, 1.0, v28
  v_add_f32 v29, 1.0, v29
  v_rcp_f32 v28, v28
  v_rcp_f32 v29, v29
  s_nop 0
  v_mul_f32 v28, v96, v28
  v_mul_f32 v29, v97, v29
  v_cvt_pk_bf16_f32 v32, v28, v29
  v_lshlrev_b32 v10, 16, v32
  v_and_b32 v11, s78, v32
  s_mov_b32 s90, 0
  s_mov_b32 s94, 0
Lps_76:
  s_add_u32 s94, s94, 1
  s_cmp_gt_u32 s94, 262144
  s_cbranch_scc1 L_end
  s_bitcmp1_b32 s90, 0
  s_cbranch_scc1 Lpk_79
  s_add_u32 s88, s99, 1114112
  buffer_load_dwordx4 v[64:67], v8, s[64:67], s88 offen sc1
Lpk_79:
  s_bitcmp1_b32 s90, 1
  s_cbranch_scc1 Lpk_80
  s_add_u32 s88, s99, 1179648
  buffer_load_dwordx4 v[68:71], v8, s[64:67], s88 offen sc1
Lpk_80:
  s_bitcmp1_b32 s90, 2
  s_cbranch_scc1 Lpk_81
  s_add_u32 s88, s99, 1245184
  buffer_load_dwordx4 v[72:75], v8, s[64:67], s88 offen sc1
Lpk_81:
  s_bitcmp1_b32 s90, 3
  s_cbranch_scc1 Lpk_82
  s_add_u32 s88, s99, 1310720
  buffer_load_dwordx4 v[76:79], v8, s[64:67], s88 offen sc1
Lpk_82:
  s_bitcmp1_b32 s90, 4
  s_cbranch_scc1 Lpk_83
  s_add_u32 s88, s99, 1376256
  buffer_load_dwordx4 v[80:83], v8, s[64:67], s88 offen sc1
Lpk_83:
  s_bitcmp1_b32 s90, 5
  s_cbranch_scc1 Lpk_84
  s_add_u32 s88, s99, 1441792
  buffer_load_dwordx4 v[84:87], v8, s[64:67], s88 offen sc1
Lpk_84:
  s_bitcmp1_b32 s90, 6
  s_cbranch_scc1 Lpk_85
  s_add_u32 s88, s99, 1507328
  buffer_load_dwordx4 v[88:91], v8, s[64:67], s88 offen sc1
Lpk_85:
  s_bitcmp1_b32 s90, 7
  s_cbranch_scc1 Lpk_86
  s_add_u32 s88, s99, 1572864
  buffer_load_dwordx4 v[92:95], v8, s[64:67], s88 offen sc1
Lpk_86:
  s_waitcnt vmcnt(0)
  v_xor_b32 v24, s71, v65
  v_xor_b32 v25, s71, v67
  v_or_b32 v24, v24, v25
  v_xor_b32 v25, s71, v69
  v_or_b32 v24, v24, v25
  v_xor_b32 v25, s71, v71
  v_or_b32 v24, v24, v25
  v_xor_b32 v25, s71, v73
  v_or_b32 v24, v24, v25
  v_xor_b32 v25, s71, v75
  v_or_b32 v24, v24, v25
  v_xor_b32 v25, s71, v77
  v_or_b32 v24, v24, v25
  v_xor_b32 v25, s71, v79
  v_or_b32 v24, v24, v25
  v_xor_b32 v25, s71, v81
  v_or_b32 v24, v24, v25
  v_xor_b32 v25, s71, v83
  v_or_b32 v24, v24, v25
  v_xor_b32 v25, s71, v85
  v_or_b32 v24, v24, v25
  v_xor_b32 v25, s71, v87
  v_or_b32 v24, v24, v25
  v_xor_b32 v25, s71, v89
  v_or_b32 v24, v24, v25
  v_xor_b32 v25, s71, v91
  v_or_b32 v24, v24, v25
  v_xor_b32 v25, s71, v93
  v_or_b32 v24, v24, v25
  v_xor_b32 v25, s71, v95
  v_or_b32 v24, v24, v25
  v_cmp_ne_u32 vcc, 0, v24
  s_cmp_lg_u64 vcc, 0
  s_cbranch_scc1 Lpb_78
  s_branch Lpd_77
Lpb_78:
  s_bitcmp1_b32 s90, 0
  s_cbranch_scc1 Lpu_87
  v_xor_b32 v24, s71, v65
  v_xor_b32 v25, s71, v67
  v_or_b32 v24, v24, v25
  v_cmp_ne_u32 vcc, 0, v24
  s_cmp_eq_u64 vcc, 0
  s_cselect_b32 s98, 1, 0
  s_or_b32 s90, s90, s98
Lpu_87:
  s_bitcmp1_b32 s90, 1
  s_cbranch_scc1 Lpu_88
  v_xor_b32 v24, s71, v69
  v_xor_b32 v25, s71, v71
  v_or_b32 v24, v24, v25
  v_cmp_ne_u32 vcc, 0, v24
  s_cmp_eq_u64 vcc, 0
  s_cselect_b32 s98, 2, 0
  s_or_b32 s90, s90, s98
Lpu_88:
  s_bitcmp1_b32 s90, 2
  s_cbranch_scc1 Lpu_89
  v_xor_b32 v24, s71, v73
  v_xor_b32 v25, s71, v75
  v_or_b32 v24, v24, v25
  v_cmp_ne_u32 vcc, 0, v24
  s_cmp_eq_u64 vcc, 0
  s_cselect_b32 s98, 4, 0
  s_or_b32 s90, s90, s98
Lpu_89:
  s_bitcmp1_b32 s90, 3
  s_cbranch_scc1 Lpu_90
  v_xor_b32 v24, s71, v77
  v_xor_b32 v25, s71, v79
  v_or_b32 v24, v24, v25
  v_cmp_ne_u32 vcc, 0, v24
  s_cmp_eq_u64 vcc, 0
  s_cselect_b32 s98, 8, 0
  s_or_b32 s90, s90, s98
Lpu_90:
  s_bitcmp1_b32 s90, 4
  s_cbranch_scc1 Lpu_91
  v_xor_b32 v24, s71, v81
  v_xor_b32 v25, s71, v83
  v_or_b32 v24, v24, v25
  v_cmp_ne_u32 vcc, 0, v24
  s_cmp_eq_u64 vcc, 0
  s_cselect_b32 s98, 16, 0
  s_or_b32 s90, s90, s98
Lpu_91:
  s_bitcmp1_b32 s90, 5
  s_cbranch_scc1 Lpu_92
  v_xor_b32 v24, s71, v85
  v_xor_b32 v25, s71, v87
  v_or_b32 v24, v24, v25
  v_cmp_ne_u32 vcc, 0, v24
  s_cmp_eq_u64 vcc, 0
  s_cselect_b32 s98, 32, 0
  s_or_b32 s90, s90, s98
Lpu_92:
  s_bitcmp1_b32 s90, 6
  s_cbranch_scc1 Lpu_93
  v_xor_b32 v24, s71, v89
  v_xor_b32 v25, s71, v91
  v_or_b32 v24, v24, v25
  v_cmp_ne_u32 vcc, 0, v24
  s_cmp_eq_u64 vcc, 0
  s_cselect_b32 s98, 64, 0
  s_or_b32 s90, s90, s98
Lpu_93:
  s_bitcmp1_b32 s90, 7
  s_cbranch_scc1 Lpu_94
  v_xor_b32 v24, s71, v93
  v_xor_b32 v25, s71, v95
  v_or_b32 v24, v24, v25
  v_cmp_ne_u32 vcc, 0, v24
  s_cmp_eq_u64 vcc, 0
  s_cselect_b32 s98, 128, 0
  s_or_b32 s90, s90, s98
Lpu_94:
  s_branch Lps_76
Lpd_77:
  v_add_f32 v64, v64, v68
  v_add_f32 v72, v72, v76
  v_add_f32 v80, v80, v84
  v_add_f32 v88, v88, v92
  v_add_f32 v66, v66, v70
  v_add_f32 v74, v74, v78
  v_add_f32 v82, v82, v86
  v_add_f32 v90, v90, v94
  v_add_f32 v64, v64, v72
  v_add_f32 v80, v80, v88
  v_add_f32 v66, v66, v74
  v_add_f32 v82, v82, v90
  v_add_f32 v64, v64, v80
  v_add_f32 v66, v66, v82
  s_nop 0
  s_nop 0
  v_add_f32_dpp v64, v64, v64 row_ror:4 row_mask:0xf bank_mask:0xf
  v_add_f32_dpp v66, v66, v66 row_ror:4 row_mask:0xf bank_mask:0xf
  s_nop 0
  v_add_f32_dpp v64, v64, v64 row_ror:8 row_mask:0xf bank_mask:0xf
  v_add_f32_dpp v66, v66, v66 row_ror:8 row_mask:0xf bank_mask:0xf
  v_mov_b32 v24, v64
  v_mov_b32 v25, v66
  s_nop 0
  s_nop 0
  v_permlane16_swap_b32 v64, v24
  v_permlane16_swap_b32 v66, v25
  v_add_f32 v64, v64, v24
  v_add_f32 v66, v66, v25
  v_mov_b32 v24, v64
  v_mov_b32 v25, v66
  s_nop 0
  s_nop 0
  v_permlane32_swap_b32 v64, v24
  v_permlane32_swap_b32 v66, v25
  v_add_f32 v64, v64, v24
  v_add_f32 v66, v66, v25
  v_cvt_pk_bf16_f32 v32, v64, v66
  v_lshlrev_b32 v64, 16, v32
  v_and_b32 v65, s78, v32
  v_mul_f32 v28, v64, v10
  v_mul_f32 v29, v65, v11
  v_cvt_pk_bf16_f32 v32, v28, v29
  v_lshlrev_b32 v28, 16, v32
  v_and_b32 v29, s78, v32
  v_add_f32 v28, v16, v28
  v_add_f32 v29, v17, v29
  v_cvt_pk_bf16_f32 v32, v28, v29
  s_lshl_b32 s73, s91, 4
  s_mov_b64 exec, 0xf
  buffer_store_dword v32, v18, s[60:63], s73 offen
  s_cmp_lg_u32 s91, 0
  s_cbranch_scc1 Lep_95
  s_mov_b64 exec, 1
  v_mov_b32 v37, s71
  buffer_store_dword v37, off, s[64:67], 0 sc1
Lep_95:
  s_mov_b64 exec, -1
L_end:
  s_endpgm
.section .rodata,"a"
.p2align 6
.amdhsa_kernel recurrent_scan__gqa_block_cached__glu_gated_geglu__decode_kernel
  .amdhsa_next_free_vgpr 256
  .amdhsa_next_free_sgpr 102
  .amdhsa_accum_offset 256
  .amdhsa_group_segment_fixed_size 0
  .amdhsa_kernarg_size 96
  .amdhsa_user_sgpr_count 2
  .amdhsa_user_sgpr_kernarg_segment_ptr 1
  .amdhsa_system_sgpr_workgroup_id_x 1
.end_amdhsa_kernel
```
